```python
import torch

def _softmax(x, axis=-1):
    return torch.softmax(x, dim=axis)
def _gelu(x):
    return torch.nn.functional.gelu(x, approximate="tanh")
def _silu(x):
    return torch.nn.functional.silu(x)
def _sigmoid(x):
    return torch.sigmoid(x)
def _layernorm(x, axis=-1, eps=1e-5):
    m = x.mean(dim=axis, keepdim=True)
    v = x.var(dim=axis, keepdim=True, unbiased=False)
    return (x - m) / torch.sqrt(v + eps)
def _scatter_add(tgt, idx, src, axis=0):
    return tgt.clone().index_add_(axis, idx, src)
def _segment_sum(src, seg, n):
    out = torch.zeros((n,) + src.shape[1:], dtype=src.dtype)
    return out.index_add_(0, seg, src)
def _pad(x, pw):
    flat = tuple(v for pair in reversed(pw) for v in pair)
    return torch.nn.functional.pad(x, flat)

kernel_name = 'recurrent_scan__mha_block_cached__glu_gated_bilinear__decode'

def setup_inputs():

    _w = (lambda a: (lambda t: t.to(torch.bfloat16) if t.is_floating_point() else t)(torch.as_tensor(a)))
    def _A_setup():
        B, Sq, D = 2, 1, 640
        H, Sk, Dh = 32, 8192, 128
        return {
            "x": _w((lambda *s: torch.randn(*s, dtype=torch.bfloat16) * 0.4)(B, Sq, D)),
            "k_cache": _w((lambda *s: torch.randn(*s, dtype=torch.bfloat16) * 1.6)(B, H, Sk, Dh)),
            "v_cache": _w((lambda *s: torch.randn(*s, dtype=torch.bfloat16) * 1.6)(B, H, Sk, Dh)),
            "wq": _w((lambda *s: torch.randn(*s, dtype=torch.bfloat16) * 1.6)(D, H * Dh) * (D ** -0.5)),
            "wo": _w((lambda *s: torch.randn(*s, dtype=torch.bfloat16) * 1.6)(H * Dh, D) * ((H * Dh) ** -0.5)),
        }
    _A_in = _A_setup()

    def _B_setup():
        B, S, D, F = 2, 1, 640, 1728
        return {
            "x": _w((lambda *s: torch.randn(*s, dtype=torch.bfloat16) * 0.4)(B, S, D)),
            "w_gate": _w((lambda *s: torch.randn(*s, dtype=torch.bfloat16) * 1.6)(D, F) * (D ** -0.5)),
            "w_up": _w((lambda *s: torch.randn(*s, dtype=torch.bfloat16) * 1.6)(D, F) * (D ** -0.5)),
            "w_down": _w((lambda *s: torch.randn(*s, dtype=torch.bfloat16) * 1.6)(F, D) * (F ** -0.5)),
        }
    _B_in = _B_setup()

    return {
        "A_x": _A_in["x"],
        "A_k_cache": _A_in["k_cache"],
        "A_v_cache": _A_in["v_cache"],
        "A_wq": _A_in["wq"],
        "A_wo": _A_in["wo"],
        "B_x": _B_in["x"],
        "B_w_gate": _B_in["w_gate"],
        "B_w_up": _B_in["w_up"],
        "B_w_down": _B_in["w_down"],
    }

def reference(A_x, A_k_cache, A_v_cache, A_wq, A_wo, B_x, B_w_gate, B_w_up, B_w_down):
    def _A_ref(x, k_cache, v_cache, wq, wo):
        B, Sq, D = x.shape
        H, Dh = 32, 128
        q = (lambda x, *d: x.permute(*d))((x @ wq).reshape(B, Sq, H, Dh), 0, 2, 1, 3)
        scores = torch.einsum("bhqd,bhkd->bhqk", q, k_cache) * (Dh ** -0.5)
        p = _softmax(scores, axis=-1)
        o = torch.einsum("bhqk,bhkd->bhqd", p, v_cache)
        return (lambda x, *d: x.permute(*d))(o, 0, 2, 1, 3).reshape(B, Sq, H * Dh) @ wo

    def _B_ref(x, w_gate, w_up, w_down):
        g = torch.einsum("bsd,df->bsf", x, w_gate)
        u = torch.einsum("bsd,df->bsf", x, w_up)
        h = g * u
        return torch.einsum("bsf,fd->bsd", h, w_down)

    x = A_x
    xn = _layernorm(x, axis=-1)
    s = _A_ref(xn, A_k_cache, A_v_cache, A_wq, A_wo)
    g = _silu(_B_ref(xn, B_w_gate, B_w_up, B_w_down))
    return x + s * g
```

```asm
; @launch grid=(256,1,1) block=(576,1,1) lds=40320
.amdgcn_target "amdgcn-amd-amdhsa--gfx950"
.text
.globl recurrent_scan__mha_block_cached__glu_gated_bilinear__decode_kernel
.p2align 8
.type recurrent_scan__mha_block_cached__glu_gated_bilinear__decode_kernel,@function
recurrent_scan__mha_block_cached__glu_gated_bilinear__decode_kernel:
    s_cmp_ge_u32 s2, 256
    s_cbranch_scc1 L_end
    s_load_dwordx2 s[8:9], s[0:1], 8
    s_load_dwordx2 s[24:25], s[0:1], 0
    s_load_dwordx2 s[16:17], s[0:1], 24
    s_load_dwordx2 s[28:29], s[0:1], 88
    s_load_dwordx2 s[12:13], s[0:1], 16
    v_lshrrev_b32 v5, 6, v0
    v_and_b32 v1, 63, v0
    v_readfirstlane_b32 s3, v5
    s_lshr_b32 s48, s2, 3
    s_and_b32 s52, s2, 7
    s_mov_b32 s10, 0x8000000
    s_mov_b32 s11, 0x20000
    s_mov_b32 s14, 0x8000000
    s_mov_b32 s15, 0x20000
    s_mov_b32 s30, 0x1bf400
    s_mov_b32 s31, 0x20000
    s_lshr_b32 s51, s3, 2
    s_mov_b32 s89, s3
    s_mov_b32 s85, s2
    s_lshl_b32 s49, s51, 5
    s_or_b32 s49, s49, s48
    s_lshr_b32 s86, s85, 3
    s_mul_i32 s87, s86, 52
    s_lshr_b32 s87, s87, 8
    s_mul_i32 s88, s87, 5
    s_sub_u32 s88, s86, s88
    s_lshl_b32 s87, s87, 3
    s_and_b32 s86, s2, 7
    s_or_b32 s87, s87, s86
    s_cmp_lt_u32 s85, 160
    s_cselect_b32 s86, 1, 0
    v_and_b32 v6, 15, v1
    v_lshrrev_b32 v7, 4, v1
    s_cmp_eq_u32 s3, 8
    s_cbranch_scc1 L_aux
    s_lshl_b32 s53, s49, 21
    v_lshlrev_b32 v2, 4, v1
    v_add_u32 v2, s53, v2
    s_lshl_b32 s54, s52, 2
    s_and_b32 s55, s89, 3
    s_or_b32 s54, s54, s55
    s_bfe_u32 s55, s54, 0x50000
    s_lshl_b32 s55, s55, 12
    s_add_u32 s57, s55, 1572864
    s_waitcnt lgkmcnt(0)
    buffer_load_dwordx4 v[80:83], v2, s[8:11], s57 offen offset:0 nt
    buffer_load_dwordx4 v[84:87], v2, s[8:11], s57 offen offset:1024 nt
    buffer_load_dwordx4 v[88:91], v2, s[8:11], s57 offen offset:2048 nt
    s_branch L_main2
L_aux:
    v_mov_b32 v31, 0
    v_lshlrev_b32 v15, 2, v6
    ds_write_b32 v15, v31 offset:37440
    s_load_dwordx2 s[20:21], s[0:1], 32
    s_load_dwordx4 s[44:47], s[0:1], 48
    s_load_dwordx2 s[40:41], s[0:1], 64
    s_load_dwordx2 s[36:37], s[0:1], 72
    s_load_dwordx2 s[32:33], s[0:1], 80
    s_mov_b32 s34, 256
    s_mov_b32 s35, 0x20000
    s_mov_b32 s26, 2560
    s_mov_b32 s27, 0x20000
    s_mov_b32 s18, 5242880
    s_mov_b32 s19, 0x20000
    v_lshlrev_b32 v13, 4, v1
    v_lshlrev_b32 v14, 2, v1
    v_and_b32 v12, 7, v6
    v_lshl_add_u32 v12, v12, 2, v7
    v_lshrrev_b32 v15, 3, v6
    v_mul_u32_u24 v15, 640, v15
    v_add_lshl_u32 v12, v12, v15, 1
    s_mul_i32 s56, s52, 160
    s_mul_i32 s57, s52, 80
    v_add_u32 v3, s57, v7
    v_lshlrev_b32 v3, 13, v3
    v_lshl_add_u32 v3, v6, 4, v3
    s_lshl_b32 s57, s48, 8
    v_add_u32 v3, s57, v3
    s_waitcnt lgkmcnt(0)
    s_cmp_eq_u32 s2, 0
    s_cbranch_scc0 L_n0
    s_memrealtime s[80:81]
    s_waitcnt lgkmcnt(0)
    s_or_b32 s80, s80, 1
    v_mov_b32 v16, s80
    v_mov_b32 v17, s81
    s_mov_b64 exec, 1
    buffer_store_dwordx2 v[16:17], off, s[32:35], 0 sc1
    s_mov_b64 exec, -1
L_n0:
    buffer_load_dwordx4 v[16:19], v13, s[24:27], 0 offen
    buffer_load_dword v20, v14, s[24:27], 0 offen offset:1024
    buffer_load_dwordx4 v[24:27], v13, s[24:27], 0 offen offset:1280
    buffer_load_dword v21, v14, s[24:27], 0 offen offset:2304
    buffer_load_ushort v28, v12, s[24:27], s56 offen
    buffer_load_ushort v29, v12, s[24:27], s56 offen offset:64
    buffer_load_ushort v30, v12, s[24:27], s56 offen offset:128
    s_mov_b32 s58, 0
    buffer_load_dwordx4 v[40:43], v3, s[16:19], s58 offen nt
    s_mov_b32 s58, 32768
    buffer_load_dwordx4 v[44:47], v3, s[16:19], s58 offen nt
    s_mov_b32 s58, 65536
    buffer_load_dwordx4 v[48:51], v3, s[16:19], s58 offen nt
    s_mov_b32 s58, 98304
    buffer_load_dwordx4 v[52:55], v3, s[16:19], s58 offen nt
    s_mov_b32 s58, 131072
    buffer_load_dwordx4 v[56:59], v3, s[16:19], s58 offen nt
    s_mov_b32 s58, 163840
    buffer_load_dwordx4 v[60:63], v3, s[16:19], s58 offen nt
    s_mov_b32 s58, 196608
    buffer_load_dwordx4 v[64:67], v3, s[16:19], s58 offen nt
    s_mov_b32 s58, 229376
    buffer_load_dwordx4 v[68:71], v3, s[16:19], s58 offen nt
    s_mov_b32 s58, 262144
    buffer_load_dwordx4 v[72:75], v3, s[16:19], s58 offen nt
    s_mov_b32 s58, 294912
    buffer_load_dwordx4 v[76:79], v3, s[16:19], s58 offen nt
    s_mov_b32 s58, 327680
    buffer_load_dwordx4 v[80:83], v3, s[16:19], s58 offen nt
    s_mov_b32 s58, 360448
    buffer_load_dwordx4 v[84:87], v3, s[16:19], s58 offen nt
    s_mov_b32 s58, 393216
    buffer_load_dwordx4 v[88:91], v3, s[16:19], s58 offen nt
    s_mov_b32 s58, 425984
    buffer_load_dwordx4 v[92:95], v3, s[16:19], s58 offen nt
    s_mov_b32 s58, 458752
    buffer_load_dwordx4 v[96:99], v3, s[16:19], s58 offen nt
    s_mov_b32 s58, 491520
    buffer_load_dwordx4 v[100:103], v3, s[16:19], s58 offen nt
    s_mov_b32 s58, 524288
    buffer_load_dwordx4 v[104:107], v3, s[16:19], s58 offen nt
    s_mov_b32 s58, 557056
    buffer_load_dwordx4 v[108:111], v3, s[16:19], s58 offen nt
    s_mov_b32 s58, 589824
    buffer_load_dwordx4 v[112:115], v3, s[16:19], s58 offen nt
    s_mov_b32 s58, 622592
    buffer_load_dwordx4 v[116:119], v3, s[16:19], s58 offen nt
    buffer_load_dwordx2 v[136:137], off, s[32:35], 0 sc1
    s_barrier
    s_mov_b32 s53, s52
    s_mov_b32 s22, 5242880
    s_mov_b32 s23, 0x20000
    s_mov_b32 s38, 2560
    s_mov_b32 s39, 0x20000
    s_mov_b32 s42, 2211840
    s_mov_b32 s43, 0x20000
    v_mov_b32 v132, -1
    v_mov_b32 v133, -1
    v_mov_b32 v134, -1
    v_mov_b32 v135, -1
    v_mov_b32 v31, 0
    v_lshlrev_b32 v15, 2, v6
    s_mul_i32 s57, s2, 1152
    s_add_u32 s57, s57, 933888
    v_lshrrev_b32 v2, 3, v1
    v_lshlrev_b32 v2, 12, v2
    v_and_b32 v15, 7, v1
    v_lshl_add_u32 v2, v15, 4, v2
    s_lshl_b32 s63, s88, 15
    s_lshl_b32 s56, s87, 7
    s_add_u32 s63, s63, s56
    v_lshrrev_b32 v4, 1, v6
    v_mul_u32_u24 v4, 7168, v4
    v_lshrrev_b32 v5, 1, v7
    v_lshl_add_u32 v4, v5, 6, v4
    v_and_b32 v5, 1, v6
    v_lshl_add_u32 v4, v5, 5, v4
    v_and_b32 v5, 1, v7
    v_lshl_add_u32 v4, v5, 4, v4
    v_bfe_u32 v5, v6, 1, 2
    v_lshlrev_b32 v5, 11, v5
    v_lshrrev_b32 v15, 3, v6
    v_lshl_add_u32 v5, v15, 7, v5
    v_and_b32 v15, 1, v6
    v_lshl_add_u32 v5, v15, 6, v5
    v_lshl_add_u32 v5, v7, 4, v5
    s_lshr_b32 s4, s85, 3
    s_lshl_b32 s5, s4, 13
    s_lshl_b32 s56, s53, 8
    s_add_u32 s5, s5, s56
    s_add_u32 s5, s5, 450560
    s_sub_u32 s6, s85, 160
    s_lshl_b32 s7, s6, 7
    s_add_u32 s7, s7, 163840
    s_mov_b32 s61, 100000
    v_and_b32 v12, 1, v6
    v_mov_b32 v15, 0xffff
    v_lshlrev_b32 v12, 4, v12
    v_lshlrev_b32 v15, v12, v15
    v_bfe_u32 v12, v6, 1, 2
    v_cmp_eq_u32 vcc, 0, v12
    s_nop 1
    v_cndmask_b32 v8, 0, v15, vcc
    v_cmp_eq_u32 vcc, 1, v12
    s_nop 1
    v_cndmask_b32 v9, 0, v15, vcc
    v_cmp_eq_u32 vcc, 2, v12
    s_nop 1
    v_cndmask_b32 v10, 0, v15, vcc
    v_cmp_eq_u32 vcc, 3, v12
    s_nop 1
    v_cndmask_b32 v11, 0, v15, vcc
    s_waitcnt vmcnt(21)
    v_lshlrev_b32 v32, 16, v16
    v_and_b32 v33, 0xffff0000, v16
    v_lshlrev_b32 v34, 16, v17
    v_and_b32 v35, 0xffff0000, v17
    v_lshlrev_b32 v36, 16, v18
    v_and_b32 v37, 0xffff0000, v18
    v_lshlrev_b32 v38, 16, v19
    v_and_b32 v39, 0xffff0000, v19
    v_lshlrev_b32 v124, 16, v20
    v_and_b32 v125, 0xffff0000, v20
    v_add_f32 v126, v32, v33
    v_add_f32 v127, v34, v35
    v_add_f32 v126, v126, v36
    v_add_f32 v127, v127, v37
    v_add_f32 v126, v126, v38
    v_add_f32 v127, v127, v39
    v_add_f32 v126, v126, v124
    v_add_f32 v127, v127, v125
    v_add_f32 v126, v126, v127
    s_nop 1
    v_add_f32_dpp v126, v126, v126 row_ror:8 row_mask:0xf bank_mask:0xf
    s_nop 1
    v_add_f32_dpp v126, v126, v126 row_ror:4 row_mask:0xf bank_mask:0xf
    s_nop 1
    v_add_f32_dpp v126, v126, v126 row_ror:2 row_mask:0xf bank_mask:0xf
    s_nop 1
    v_add_f32_dpp v126, v126, v126 row_ror:1 row_mask:0xf bank_mask:0xf
    s_nop 1
    v_add_f32_dpp v126, v126, v126 row_bcast:15 row_mask:0xa bank_mask:0xf
    s_nop 1
    v_add_f32_dpp v126, v126, v126 row_bcast:31 row_mask:0xc bank_mask:0xf
    s_nop 0
    v_readlane_b32 s59, v126, 63
    v_mov_b32 v128, 0x3acccccd
    s_nop 0
    v_mul_f32 v128, s59, v128
    v_sub_f32 v127, v32, v128
    v_mul_f32 v126, v127, v127
    v_sub_f32 v127, v33, v128
    v_fmac_f32 v126, v127, v127
    v_sub_f32 v127, v34, v128
    v_fmac_f32 v126, v127, v127
    v_sub_f32 v127, v35, v128
    v_fmac_f32 v126, v127, v127
    v_sub_f32 v127, v36, v128
    v_fmac_f32 v126, v127, v127
    v_sub_f32 v127, v37, v128
    v_fmac_f32 v126, v127, v127
    v_sub_f32 v127, v38, v128
    v_fmac_f32 v126, v127, v127
    v_sub_f32 v127, v39, v128
    v_fmac_f32 v126, v127, v127
    v_sub_f32 v127, v124, v128
    v_fmac_f32 v126, v127, v127
    v_sub_f32 v127, v125, v128
    v_fmac_f32 v126, v127, v127
    s_nop 1
    v_add_f32_dpp v126, v126, v126 row_ror:8 row_mask:0xf bank_mask:0xf
    s_nop 1
    v_add_f32_dpp v126, v126, v126 row_ror:4 row_mask:0xf bank_mask:0xf
    s_nop 1
    v_add_f32_dpp v126, v126, v126 row_ror:2 row_mask:0xf bank_mask:0xf
    s_nop 1
    v_add_f32_dpp v126, v126, v126 row_ror:1 row_mask:0xf bank_mask:0xf
    s_nop 1
    v_add_f32_dpp v126, v126, v126 row_bcast:15 row_mask:0xa bank_mask:0xf
    s_nop 1
    v_add_f32_dpp v126, v126, v126 row_bcast:31 row_mask:0xc bank_mask:0xf
    s_nop 0
    v_readlane_b32 s59, v126, 63
    v_mov_b32 v129, 0x3acccccd
    s_nop 0
    v_mul_f32 v129, s59, v129
    v_cvt_pk_bf16_f32 v128, v128, v128
    v_and_b32 v128, 0xffff0000, v128
    v_cvt_pk_bf16_f32 v129, v129, v129
    v_and_b32 v129, 0xffff0000, v129
    v_add_f32 v129, 0x3727c5ac, v129
    v_cvt_pk_bf16_f32 v129, v129, v129
    v_and_b32 v129, 0xffff0000, v129
    v_sqrt_f32 v129, v129
    s_nop 0
    v_cvt_pk_bf16_f32 v129, v129, v129
    v_and_b32 v129, 0xffff0000, v129
    v_rcp_f32 v130, v129
    v_lshlrev_b32 v32, 16, v24
    v_and_b32 v33, 0xffff0000, v24
    v_lshlrev_b32 v34, 16, v25
    v_and_b32 v35, 0xffff0000, v25
    v_lshlrev_b32 v36, 16, v26
    v_and_b32 v37, 0xffff0000, v26
    v_lshlrev_b32 v38, 16, v27
    v_and_b32 v39, 0xffff0000, v27
    v_lshlrev_b32 v124, 16, v21
    v_and_b32 v125, 0xffff0000, v21
    v_add_f32 v126, v32, v33
    v_add_f32 v127, v34, v35
    v_add_f32 v126, v126, v36
    v_add_f32 v127, v127, v37
    v_add_f32 v126, v126, v38
    v_add_f32 v127, v127, v39
    v_add_f32 v126, v126, v124
    v_add_f32 v127, v127, v125
    v_add_f32 v126, v126, v127
    s_nop 1
    v_add_f32_dpp v126, v126, v126 row_ror:8 row_mask:0xf bank_mask:0xf
    s_nop 1
    v_add_f32_dpp v126, v126, v126 row_ror:4 row_mask:0xf bank_mask:0xf
    s_nop 1
    v_add_f32_dpp v126, v126, v126 row_ror:2 row_mask:0xf bank_mask:0xf
    s_nop 1
    v_add_f32_dpp v126, v126, v126 row_ror:1 row_mask:0xf bank_mask:0xf
    s_nop 1
    v_add_f32_dpp v126, v126, v126 row_bcast:15 row_mask:0xa bank_mask:0xf
    s_nop 1
    v_add_f32_dpp v126, v126, v126 row_bcast:31 row_mask:0xc bank_mask:0xf
    s_nop 0
    v_readlane_b32 s59, v126, 63
    v_mov_b32 v16, 0x3acccccd
    s_nop 0
    v_mul_f32 v16, s59, v16
    v_sub_f32 v127, v32, v16
    v_mul_f32 v126, v127, v127
    v_sub_f32 v127, v33, v16
    v_fmac_f32 v126, v127, v127
    v_sub_f32 v127, v34, v16
    v_fmac_f32 v126, v127, v127
    v_sub_f32 v127, v35, v16
    v_fmac_f32 v126, v127, v127
    v_sub_f32 v127, v36, v16
    v_fmac_f32 v126, v127, v127
    v_sub_f32 v127, v37, v16
    v_fmac_f32 v126, v127, v127
    v_sub_f32 v127, v38, v16
    v_fmac_f32 v126, v127, v127
    v_sub_f32 v127, v39, v16
    v_fmac_f32 v126, v127, v127
    v_sub_f32 v127, v124, v16
    v_fmac_f32 v126, v127, v127
    v_sub_f32 v127, v125, v16
    v_fmac_f32 v126, v127, v127
    s_nop 1
    v_add_f32_dpp v126, v126, v126 row_ror:8 row_mask:0xf bank_mask:0xf
    s_nop 1
    v_add_f32_dpp v126, v126, v126 row_ror:4 row_mask:0xf bank_mask:0xf
    s_nop 1
    v_add_f32_dpp v126, v126, v126 row_ror:2 row_mask:0xf bank_mask:0xf
    s_nop 1
    v_add_f32_dpp v126, v126, v126 row_ror:1 row_mask:0xf bank_mask:0xf
    s_nop 1
    v_add_f32_dpp v126, v126, v126 row_bcast:15 row_mask:0xa bank_mask:0xf
    s_nop 1
    v_add_f32_dpp v126, v126, v126 row_bcast:31 row_mask:0xc bank_mask:0xf
    s_nop 0
    v_readlane_b32 s59, v126, 63
    v_mov_b32 v17, 0x3acccccd
    s_nop 0
    v_mul_f32 v17, s59, v17
    v_cvt_pk_bf16_f32 v16, v16, v16
    v_and_b32 v16, 0xffff0000, v16
    v_cvt_pk_bf16_f32 v17, v17, v17
    v_and_b32 v17, 0xffff0000, v17
    v_add_f32 v17, 0x3727c5ac, v17
    v_cvt_pk_bf16_f32 v17, v17, v17
    v_and_b32 v17, 0xffff0000, v17
    v_sqrt_f32 v17, v17
    s_nop 0
    v_cvt_pk_bf16_f32 v17, v17, v17
    v_and_b32 v17, 0xffff0000, v17
    v_rcp_f32 v18, v17
    v_cmp_lt_u32 vcc, 7, v6
    s_nop 1
    v_cndmask_b32 v128, v128, v16, vcc
    v_cndmask_b32 v129, v129, v17, vcc
    v_cndmask_b32 v130, v130, v18, vcc
    v_lshlrev_b32 v28, 16, v28
    v_sub_f32 v32, v28, v128
    v_cvt_pk_bf16_f32 v32, v32, v32
    v_and_b32 v32, 0xffff0000, v32
    v_mul_f32 v33, v32, v130
    v_fma_f32 v32, -v33, v129, v32
    v_fma_f32 v33, v32, v130, v33
    v_cvt_pk_bf16_f32 v28, v33, v33
    v_lshlrev_b32 v29, 16, v29
    v_sub_f32 v32, v29, v128
    v_cvt_pk_bf16_f32 v32, v32, v32
    v_and_b32 v32, 0xffff0000, v32
    v_mul_f32 v33, v32, v130
    v_fma_f32 v32, -v33, v129, v32
    v_fma_f32 v33, v32, v130, v33
    v_cvt_pk_bf16_f32 v29, v33, v33
    v_lshlrev_b32 v30, 16, v30
    v_sub_f32 v32, v30, v128
    v_cvt_pk_bf16_f32 v32, v32, v32
    v_and_b32 v32, 0xffff0000, v32
    v_mul_f32 v33, v32, v130
    v_fma_f32 v32, -v33, v129, v32
    v_fma_f32 v33, v32, v130, v33
    v_cvt_pk_bf16_f32 v30, v33, v33
    v_mov_b32_dpp v24, v28 row_newbcast:0 row_mask:0xf bank_mask:0x3
    s_nop 1
    v_mov_b32_dpp v24, v28 row_newbcast:8 row_mask:0xf bank_mask:0xc
    v_and_b32 v32, v24, v8
    v_and_b32 v33, v24, v9
    v_and_b32 v34, v24, v10
    v_and_b32 v35, v24, v11
    s_waitcnt vmcnt(20)
    s_nop 0
    v_mfma_f32_16x16x32_bf16 v[20:23], v[32:35], v[40:43], 0
    v_mov_b32_dpp v24, v28 row_newbcast:1 row_mask:0xf bank_mask:0x3
    s_nop 1
    v_mov_b32_dpp v24, v28 row_newbcast:9 row_mask:0xf bank_mask:0xc
    v_and_b32 v36, v24, v8
    v_and_b32 v37, v24, v9
    v_and_b32 v38, v24, v10
    v_and_b32 v39, v24, v11
    s_waitcnt vmcnt(19)
    s_nop 0
    v_mfma_f32_16x16x32_bf16 v[20:23], v[36:39], v[44:47], v[20:23]
    v_mov_b32_dpp v24, v28 row_newbcast:2 row_mask:0xf bank_mask:0x3
    s_nop 1
    v_mov_b32_dpp v24, v28 row_newbcast:10 row_mask:0xf bank_mask:0xc
    v_and_b32 v32, v24, v8
    v_and_b32 v33, v24, v9
    v_and_b32 v34, v24, v10
    v_and_b32 v35, v24, v11
    s_waitcnt vmcnt(18)
    s_nop 0
    v_mfma_f32_16x16x32_bf16 v[20:23], v[32:35], v[48:51], v[20:23]
    v_mov_b32_dpp v24, v28 row_newbcast:3 row_mask:0xf bank_mask:0x3
    s_nop 1
    v_mov_b32_dpp v24, v28 row_newbcast:11 row_mask:0xf bank_mask:0xc
    v_and_b32 v36, v24, v8
    v_and_b32 v37, v24, v9
    v_and_b32 v38, v24, v10
    v_and_b32 v39, v24, v11
    s_waitcnt vmcnt(17)
    s_nop 0
    v_mfma_f32_16x16x32_bf16 v[20:23], v[36:39], v[52:55], v[20:23]
    v_mov_b32_dpp v24, v28 row_newbcast:4 row_mask:0xf bank_mask:0x3
    s_nop 1
    v_mov_b32_dpp v24, v28 row_newbcast:12 row_mask:0xf bank_mask:0xc
    v_and_b32 v32, v24, v8
    v_and_b32 v33, v24, v9
    v_and_b32 v34, v24, v10
    v_and_b32 v35, v24, v11
    s_waitcnt vmcnt(16)
    s_nop 0
    v_mfma_f32_16x16x32_bf16 v[20:23], v[32:35], v[56:59], v[20:23]
    v_mov_b32_dpp v24, v28 row_newbcast:5 row_mask:0xf bank_mask:0x3
    s_nop 1
    v_mov_b32_dpp v24, v28 row_newbcast:13 row_mask:0xf bank_mask:0xc
    v_and_b32 v36, v24, v8
    v_and_b32 v37, v24, v9
    v_and_b32 v38, v24, v10
    v_and_b32 v39, v24, v11
    s_waitcnt vmcnt(15)
    s_nop 0
    v_mfma_f32_16x16x32_bf16 v[20:23], v[36:39], v[60:63], v[20:23]
    v_mov_b32_dpp v24, v28 row_newbcast:6 row_mask:0xf bank_mask:0x3
    s_nop 1
    v_mov_b32_dpp v24, v28 row_newbcast:14 row_mask:0xf bank_mask:0xc
    v_and_b32 v32, v24, v8
    v_and_b32 v33, v24, v9
    v_and_b32 v34, v24, v10
    v_and_b32 v35, v24, v11
    s_waitcnt vmcnt(14)
    s_nop 0
    v_mfma_f32_16x16x32_bf16 v[20:23], v[32:35], v[64:67], v[20:23]
    v_mov_b32_dpp v24, v28 row_newbcast:7 row_mask:0xf bank_mask:0x3
    s_nop 1
    v_mov_b32_dpp v24, v28 row_newbcast:15 row_mask:0xf bank_mask:0xc
    v_and_b32 v36, v24, v8
    v_and_b32 v37, v24, v9
    v_and_b32 v38, v24, v10
    v_and_b32 v39, v24, v11
    s_waitcnt vmcnt(13)
    s_nop 0
    v_mfma_f32_16x16x32_bf16 v[20:23], v[36:39], v[68:71], v[20:23]
    v_mov_b32_dpp v24, v29 row_newbcast:0 row_mask:0xf bank_mask:0x3
    s_nop 1
    v_mov_b32_dpp v24, v29 row_newbcast:8 row_mask:0xf bank_mask:0xc
    v_and_b32 v32, v24, v8
    v_and_b32 v33, v24, v9
    v_and_b32 v34, v24, v10
    v_and_b32 v35, v24, v11
    s_waitcnt vmcnt(12)
    s_nop 0
    v_mfma_f32_16x16x32_bf16 v[20:23], v[32:35], v[72:75], v[20:23]
    v_mov_b32_dpp v24, v29 row_newbcast:1 row_mask:0xf bank_mask:0x3
    s_nop 1
    v_mov_b32_dpp v24, v29 row_newbcast:9 row_mask:0xf bank_mask:0xc
    v_and_b32 v36, v24, v8
    v_and_b32 v37, v24, v9
    v_and_b32 v38, v24, v10
    v_and_b32 v39, v24, v11
    s_waitcnt vmcnt(11)
    s_nop 0
    v_mfma_f32_16x16x32_bf16 v[20:23], v[36:39], v[76:79], v[20:23]
    v_mov_b32_dpp v24, v29 row_newbcast:2 row_mask:0xf bank_mask:0x3
    s_nop 1
    v_mov_b32_dpp v24, v29 row_newbcast:10 row_mask:0xf bank_mask:0xc
    v_and_b32 v32, v24, v8
    v_and_b32 v33, v24, v9
    v_and_b32 v34, v24, v10
    v_and_b32 v35, v24, v11
    s_waitcnt vmcnt(10)
    s_nop 0
    v_mfma_f32_16x16x32_bf16 v[20:23], v[32:35], v[80:83], v[20:23]
    v_mov_b32_dpp v24, v29 row_newbcast:3 row_mask:0xf bank_mask:0x3
    s_nop 1
    v_mov_b32_dpp v24, v29 row_newbcast:11 row_mask:0xf bank_mask:0xc
    v_and_b32 v36, v24, v8
    v_and_b32 v37, v24, v9
    v_and_b32 v38, v24, v10
    v_and_b32 v39, v24, v11
    s_waitcnt vmcnt(9)
    s_nop 0
    v_mfma_f32_16x16x32_bf16 v[20:23], v[36:39], v[84:87], v[20:23]
    v_mov_b32_dpp v24, v29 row_newbcast:4 row_mask:0xf bank_mask:0x3
    s_nop 1
    v_mov_b32_dpp v24, v29 row_newbcast:12 row_mask:0xf bank_mask:0xc
    v_and_b32 v32, v24, v8
    v_and_b32 v33, v24, v9
    v_and_b32 v34, v24, v10
    v_and_b32 v35, v24, v11
    s_waitcnt vmcnt(8)
    s_nop 0
    v_mfma_f32_16x16x32_bf16 v[20:23], v[32:35], v[88:91], v[20:23]
    v_mov_b32_dpp v24, v29 row_newbcast:5 row_mask:0xf bank_mask:0x3
    s_nop 1
    v_mov_b32_dpp v24, v29 row_newbcast:13 row_mask:0xf bank_mask:0xc
    v_and_b32 v36, v24, v8
    v_and_b32 v37, v24, v9
    v_and_b32 v38, v24, v10
    v_and_b32 v39, v24, v11
    s_waitcnt vmcnt(7)
    s_nop 0
    v_mfma_f32_16x16x32_bf16 v[20:23], v[36:39], v[92:95], v[20:23]
    v_mov_b32_dpp v24, v29 row_newbcast:6 row_mask:0xf bank_mask:0x3
    s_nop 1
    v_mov_b32_dpp v24, v29 row_newbcast:14 row_mask:0xf bank_mask:0xc
    v_and_b32 v32, v24, v8
    v_and_b32 v33, v24, v9
    v_and_b32 v34, v24, v10
    v_and_b32 v35, v24, v11
    s_waitcnt vmcnt(6)
    s_nop 0
    v_mfma_f32_16x16x32_bf16 v[20:23], v[32:35], v[96:99], v[20:23]
    v_mov_b32_dpp v24, v29 row_newbcast:7 row_mask:0xf bank_mask:0x3
    s_nop 1
    v_mov_b32_dpp v24, v29 row_newbcast:15 row_mask:0xf bank_mask:0xc
    v_and_b32 v36, v24, v8
    v_and_b32 v37, v24, v9
    v_and_b32 v38, v24, v10
    v_and_b32 v39, v24, v11
    s_waitcnt vmcnt(5)
    s_nop 0
    v_mfma_f32_16x16x32_bf16 v[20:23], v[36:39], v[100:103], v[20:23]
    v_mov_b32_dpp v24, v30 row_newbcast:0 row_mask:0xf bank_mask:0x3
    s_nop 1
    v_mov_b32_dpp v24, v30 row_newbcast:8 row_mask:0xf bank_mask:0xc
    v_and_b32 v32, v24, v8
    v_and_b32 v33, v24, v9
    v_and_b32 v34, v24, v10
    v_and_b32 v35, v24, v11
    s_waitcnt vmcnt(4)
    s_nop 0
    v_mfma_f32_16x16x32_bf16 v[20:23], v[32:35], v[104:107], v[20:23]
    v_mov_b32_dpp v24, v30 row_newbcast:1 row_mask:0xf bank_mask:0x3
    s_nop 1
    v_mov_b32_dpp v24, v30 row_newbcast:9 row_mask:0xf bank_mask:0xc
    v_and_b32 v36, v24, v8
    v_and_b32 v37, v24, v9
    v_and_b32 v38, v24, v10
    v_and_b32 v39, v24, v11
    s_waitcnt vmcnt(3)
    s_nop 0
    v_mfma_f32_16x16x32_bf16 v[20:23], v[36:39], v[108:111], v[20:23]
    v_mov_b32_dpp v24, v30 row_newbcast:2 row_mask:0xf bank_mask:0x3
    s_nop 1
    v_mov_b32_dpp v24, v30 row_newbcast:10 row_mask:0xf bank_mask:0xc
    v_and_b32 v32, v24, v8
    v_and_b32 v33, v24, v9
    v_and_b32 v34, v24, v10
    v_and_b32 v35, v24, v11
    s_waitcnt vmcnt(2)
    s_nop 0
    v_mfma_f32_16x16x32_bf16 v[20:23], v[32:35], v[112:115], v[20:23]
    v_mov_b32_dpp v24, v30 row_newbcast:3 row_mask:0xf bank_mask:0x3
    s_nop 1
    v_mov_b32_dpp v24, v30 row_newbcast:11 row_mask:0xf bank_mask:0xc
    v_and_b32 v36, v24, v8
    v_and_b32 v37, v24, v9
    v_and_b32 v38, v24, v10
    v_and_b32 v39, v24, v11
    s_waitcnt vmcnt(1)
    s_nop 0
    v_mfma_f32_16x16x32_bf16 v[20:23], v[36:39], v[116:119], v[20:23]
    buffer_store_dwordx4 v[132:135], v13, s[28:31], s57 offen sc1
    s_mov_b64 exec, 0xff
    buffer_store_dwordx4 v[132:135], v13, s[28:31], s57 offen offset:1024 sc1
    s_mov_b64 exec, -1
    s_cmp_eq_u32 s86, 1
    s_cbranch_scc0 L_c1
    buffer_store_dwordx4 v[132:135], v2, s[28:31], s63 offen sc1
L_c1:
    s_cmp_eq_u32 s52, 0
    s_cbranch_scc0 L_c2
    s_lshl_b32 s56, s48, 10
    s_add_u32 s56, s56, 1228800
    v_lshlrev_b32 v12, 15, v1
    s_mov_b64 exec, 3
    buffer_store_dword v31, v12, s[28:31], s56 offen sc1
    s_mov_b64 exec, -1
L_c2:
    v_lshrrev_b32 v12, 1, v7
    v_lshlrev_b32 v12, 9, v12
    v_lshl_add_u32 v12, v6, 5, v12
    v_and_b32 v13, 1, v7
    v_lshl_add_u32 v12, v13, 4, v12
    s_lshl_b32 s56, s2, 10
    s_add_u32 s56, s56, 671744
    s_nop 1
    buffer_store_dwordx4 v[20:23], v12, s[28:31], s56 offen sc1
    v_lshlrev_b32 v12, 4, v1
    v_add_u32 v13, 4096, v12
    v_lshlrev_b32 v14, 3, v1
    v_and_b32 v15, 7, v1
    s_lshl_b32 s57, s48, 3
    v_add_lshl_u32 v15, v15, s57, 4
    s_lshl_b32 s57, s48, 13
    s_add_u32 s57, s57, 671744
    s_waitcnt vmcnt(0)
L_m0:
    v_cmp_eq_u32 vcc, 0, v136
    s_cbranch_vccz L_m1
    s_cmp_eq_u32 s61, 0
    s_cbranch_scc1 L_m1
    s_sub_u32 s61, s61, 1
    s_sleep 4
    buffer_load_dwordx2 v[136:137], off, s[32:35], 0 sc1
    s_waitcnt vmcnt(0)
    s_branch L_m0
L_m1:
    s_lshl_b32 s56, s2, 4
    s_add_u32 s56, s56, 1294336
    s_waitcnt vmcnt(0)
    s_mov_b64 exec, 1
    buffer_store_dwordx2 v[136:137], off, s[28:31], s56 sc1
    s_mov_b64 exec, -1
    s_mov_b32 s56, 1294336
L_q1:
    buffer_load_dwordx2 v[16:17], v15, s[28:31], s56 offen sc1
    s_waitcnt vmcnt(0)
    v_cmp_ne_u64 vcc, v[16:17], v[136:137]
    s_cbranch_vccz L_q1_ok
    s_cmp_eq_u32 s61, 0
    s_cbranch_scc1 L_q1_ok
    s_sub_u32 s61, s61, 1
    s_sleep 4
    s_branch L_q1
L_q1_ok:
    buffer_load_dwordx4 v[40:43], v12, s[28:31], s57 offen offset:0 sc1
    buffer_load_dwordx4 v[44:47], v12, s[28:31], s57 offen offset:1024 sc1
    buffer_load_dwordx4 v[48:51], v12, s[28:31], s57 offen offset:2048 sc1
    buffer_load_dwordx4 v[52:55], v12, s[28:31], s57 offen offset:3072 sc1
    buffer_load_dwordx4 v[56:59], v13, s[28:31], s57 offen offset:0 sc1
    buffer_load_dwordx4 v[60:63], v13, s[28:31], s57 offen offset:1024 sc1
    buffer_load_dwordx4 v[64:67], v13, s[28:31], s57 offen offset:2048 sc1
    buffer_load_dwordx4 v[68:71], v13, s[28:31], s57 offen offset:3072 sc1
    s_waitcnt vmcnt(6)
    v_add_f32 v40, v40, v44
    v_add_f32 v41, v41, v45
    v_add_f32 v42, v42, v46
    v_add_f32 v43, v43, v47
    s_waitcnt vmcnt(4)
    v_add_f32 v48, v48, v52
    v_add_f32 v49, v49, v53
    v_add_f32 v50, v50, v54
    v_add_f32 v51, v51, v55
    s_waitcnt vmcnt(2)
    v_add_f32 v56, v56, v60
    v_add_f32 v57, v57, v61
    v_add_f32 v58, v58, v62
    v_add_f32 v59, v59, v63
    s_waitcnt vmcnt(0)
    v_add_f32 v64, v64, v68
    v_add_f32 v65, v65, v69
    v_add_f32 v66, v66, v70
    v_add_f32 v67, v67, v71
    v_add_f32 v40, v40, v48
    v_add_f32 v41, v41, v49
    v_add_f32 v42, v42, v50
    v_add_f32 v43, v43, v51
    v_add_f32 v56, v56, v64
    v_add_f32 v57, v57, v65
    v_add_f32 v58, v58, v66
    v_add_f32 v59, v59, v67
    v_add_f32 v16, v40, v56
    v_add_f32 v17, v41, v57
    v_add_f32 v18, v42, v58
    v_add_f32 v19, v43, v59
    v_cvt_pk_bf16_f32 v16, v16, v17
    v_cvt_pk_bf16_f32 v17, v18, v19
    ds_write_b64 v14, v[16:17] offset:36928
    v_mov_b32 v16, 1
    s_waitcnt lgkmcnt(0)
    ds_write_b32 v31, v16 offset:37456
    s_cmp_lt_u32 s85, 216
    s_cbranch_scc0 L_g1done
    s_mul_i32 s56, s53, 80
    v_mov_b32 v2, s44
    v_mov_b32 v3, s45
    v_mov_b32 v14, s46
    v_mov_b32 v15, s47
    v_cmp_lt_u32 vcc, 7, v6
    s_nop 1
    v_cndmask_b32 v2, v2, v14, vcc
    v_cndmask_b32 v3, v3, v15, vcc
    v_add_u32 v14, s56, v7
    v_mul_u32_u24 v14, 3456, v14
    v_and_b32 v15, 7, v6
    v_lshl_add_u32 v14, v15, 4, v14
    s_lshl_b32 s56, s4, 7
    v_add_u32 v14, s56, v14
    v_mov_b32 v15, 0
    v_lshl_add_u64 v[2:3], v[2:3], 0, v[14:15]
    s_mov_b32 s56, 13824
    s_mov_b32 s57, 0
    global_load_dwordx4 v[40:43], v[2:3], off nt
    v_lshl_add_u64 v[2:3], v[2:3], 0, s[56:57]
    global_load_dwordx4 v[44:47], v[2:3], off nt
    v_lshl_add_u64 v[2:3], v[2:3], 0, s[56:57]
    global_load_dwordx4 v[48:51], v[2:3], off nt
    v_lshl_add_u64 v[2:3], v[2:3], 0, s[56:57]
    global_load_dwordx4 v[52:55], v[2:3], off nt
    v_lshl_add_u64 v[2:3], v[2:3], 0, s[56:57]
    global_load_dwordx4 v[56:59], v[2:3], off nt
    v_lshl_add_u64 v[2:3], v[2:3], 0, s[56:57]
    global_load_dwordx4 v[60:63], v[2:3], off nt
    v_lshl_add_u64 v[2:3], v[2:3], 0, s[56:57]
    global_load_dwordx4 v[64:67], v[2:3], off nt
    v_lshl_add_u64 v[2:3], v[2:3], 0, s[56:57]
    global_load_dwordx4 v[68:71], v[2:3], off nt
    v_lshl_add_u64 v[2:3], v[2:3], 0, s[56:57]
    global_load_dwordx4 v[72:75], v[2:3], off nt
    v_lshl_add_u64 v[2:3], v[2:3], 0, s[56:57]
    global_load_dwordx4 v[76:79], v[2:3], off nt
    v_lshl_add_u64 v[2:3], v[2:3], 0, s[56:57]
    v_mov_b32_dpp v24, v28 row_newbcast:0 row_mask:0xf bank_mask:0x3
    s_nop 1
    v_mov_b32_dpp v24, v28 row_newbcast:8 row_mask:0xf bank_mask:0xc
    v_and_b32 v32, v24, v8
    v_and_b32 v33, v24, v9
    v_and_b32 v34, v24, v10
    v_and_b32 v35, v24, v11
    s_waitcnt vmcnt(9)
    global_load_dwordx4 v[80:83], v[2:3], off nt
    v_lshl_add_u64 v[2:3], v[2:3], 0, s[56:57]
    v_mfma_f32_16x16x32_bf16 v[20:23], v[32:35], v[40:43], 0
    v_mov_b32_dpp v24, v28 row_newbcast:1 row_mask:0xf bank_mask:0x3
    s_nop 1
    v_mov_b32_dpp v24, v28 row_newbcast:9 row_mask:0xf bank_mask:0xc
    v_and_b32 v36, v24, v8
    v_and_b32 v37, v24, v9
    v_and_b32 v38, v24, v10
    v_and_b32 v39, v24, v11
    s_waitcnt vmcnt(9)
    global_load_dwordx4 v[84:87], v[2:3], off nt
    v_lshl_add_u64 v[2:3], v[2:3], 0, s[56:57]
    v_mfma_f32_16x16x32_bf16 v[20:23], v[36:39], v[44:47], v[20:23]
    v_mov_b32_dpp v24, v28 row_newbcast:2 row_mask:0xf bank_mask:0x3
    s_nop 1
    v_mov_b32_dpp v24, v28 row_newbcast:10 row_mask:0xf bank_mask:0xc
    v_and_b32 v32, v24, v8
    v_and_b32 v33, v24, v9
    v_and_b32 v34, v24, v10
    v_and_b32 v35, v24, v11
    s_waitcnt vmcnt(9)
    global_load_dwordx4 v[88:91], v[2:3], off nt
    v_lshl_add_u64 v[2:3], v[2:3], 0, s[56:57]
    v_mfma_f32_16x16x32_bf16 v[20:23], v[32:35], v[48:51], v[20:23]
    v_mov_b32_dpp v24, v28 row_newbcast:3 row_mask:0xf bank_mask:0x3
    s_nop 1
    v_mov_b32_dpp v24, v28 row_newbcast:11 row_mask:0xf bank_mask:0xc
    v_and_b32 v36, v24, v8
    v_and_b32 v37, v24, v9
    v_and_b32 v38, v24, v10
    v_and_b32 v39, v24, v11
    s_waitcnt vmcnt(9)
    global_load_dwordx4 v[92:95], v[2:3], off nt
    v_lshl_add_u64 v[2:3], v[2:3], 0, s[56:57]
    v_mfma_f32_16x16x32_bf16 v[20:23], v[36:39], v[52:55], v[20:23]
    v_mov_b32_dpp v24, v28 row_newbcast:4 row_mask:0xf bank_mask:0x3
    s_nop 1
    v_mov_b32_dpp v24, v28 row_newbcast:12 row_mask:0xf bank_mask:0xc
    v_and_b32 v32, v24, v8
    v_and_b32 v33, v24, v9
    v_and_b32 v34, v24, v10
    v_and_b32 v35, v24, v11
    s_waitcnt vmcnt(9)
    global_load_dwordx4 v[96:99], v[2:3], off nt
    v_lshl_add_u64 v[2:3], v[2:3], 0, s[56:57]
    v_mfma_f32_16x16x32_bf16 v[20:23], v[32:35], v[56:59], v[20:23]
    v_mov_b32_dpp v24, v28 row_newbcast:5 row_mask:0xf bank_mask:0x3
    s_nop 1
    v_mov_b32_dpp v24, v28 row_newbcast:13 row_mask:0xf bank_mask:0xc
    v_and_b32 v36, v24, v8
    v_and_b32 v37, v24, v9
    v_and_b32 v38, v24, v10
    v_and_b32 v39, v24, v11
    s_waitcnt vmcnt(9)
    global_load_dwordx4 v[100:103], v[2:3], off nt
    v_lshl_add_u64 v[2:3], v[2:3], 0, s[56:57]
    v_mfma_f32_16x16x32_bf16 v[20:23], v[36:39], v[60:63], v[20:23]
    v_mov_b32_dpp v24, v28 row_newbcast:6 row_mask:0xf bank_mask:0x3
    s_nop 1
    v_mov_b32_dpp v24, v28 row_newbcast:14 row_mask:0xf bank_mask:0xc
    v_and_b32 v32, v24, v8
    v_and_b32 v33, v24, v9
    v_and_b32 v34, v24, v10
    v_and_b32 v35, v24, v11
    s_waitcnt vmcnt(9)
    global_load_dwordx4 v[104:107], v[2:3], off nt
    v_lshl_add_u64 v[2:3], v[2:3], 0, s[56:57]
    v_mfma_f32_16x16x32_bf16 v[20:23], v[32:35], v[64:67], v[20:23]
    v_mov_b32_dpp v24, v28 row_newbcast:7 row_mask:0xf bank_mask:0x3
    s_nop 1
    v_mov_b32_dpp v24, v28 row_newbcast:15 row_mask:0xf bank_mask:0xc
    v_and_b32 v36, v24, v8
    v_and_b32 v37, v24, v9
    v_and_b32 v38, v24, v10
    v_and_b32 v39, v24, v11
    s_waitcnt vmcnt(9)
    global_load_dwordx4 v[108:111], v[2:3], off nt
    v_lshl_add_u64 v[2:3], v[2:3], 0, s[56:57]
    v_mfma_f32_16x16x32_bf16 v[20:23], v[36:39], v[68:71], v[20:23]
    v_mov_b32_dpp v24, v29 row_newbcast:0 row_mask:0xf bank_mask:0x3
    s_nop 1
    v_mov_b32_dpp v24, v29 row_newbcast:8 row_mask:0xf bank_mask:0xc
    v_and_b32 v32, v24, v8
    v_and_b32 v33, v24, v9
    v_and_b32 v34, v24, v10
    v_and_b32 v35, v24, v11
    s_waitcnt vmcnt(9)
    global_load_dwordx4 v[112:115], v[2:3], off nt
    v_lshl_add_u64 v[2:3], v[2:3], 0, s[56:57]
    v_mfma_f32_16x16x32_bf16 v[20:23], v[32:35], v[72:75], v[20:23]
    v_mov_b32_dpp v24, v29 row_newbcast:1 row_mask:0xf bank_mask:0x3
    s_nop 1
    v_mov_b32_dpp v24, v29 row_newbcast:9 row_mask:0xf bank_mask:0xc
    v_and_b32 v36, v24, v8
    v_and_b32 v37, v24, v9
    v_and_b32 v38, v24, v10
    v_and_b32 v39, v24, v11
    s_waitcnt vmcnt(9)
    global_load_dwordx4 v[116:119], v[2:3], off nt
    v_mfma_f32_16x16x32_bf16 v[20:23], v[36:39], v[76:79], v[20:23]
    v_mov_b32_dpp v24, v29 row_newbcast:2 row_mask:0xf bank_mask:0x3
    s_nop 1
    v_mov_b32_dpp v24, v29 row_newbcast:10 row_mask:0xf bank_mask:0xc
    v_and_b32 v32, v24, v8
    v_and_b32 v33, v24, v9
    v_and_b32 v34, v24, v10
    v_and_b32 v35, v24, v11
    s_waitcnt vmcnt(9)
    s_nop 0
    v_mfma_f32_16x16x32_bf16 v[20:23], v[32:35], v[80:83], v[20:23]
    v_mov_b32_dpp v24, v29 row_newbcast:3 row_mask:0xf bank_mask:0x3
    s_nop 1
    v_mov_b32_dpp v24, v29 row_newbcast:11 row_mask:0xf bank_mask:0xc
    v_and_b32 v36, v24, v8
    v_and_b32 v37, v24, v9
    v_and_b32 v38, v24, v10
    v_and_b32 v39, v24, v11
    s_waitcnt vmcnt(8)
    s_nop 0
    v_mfma_f32_16x16x32_bf16 v[20:23], v[36:39], v[84:87], v[20:23]
    v_mov_b32_dpp v24, v29 row_newbcast:4 row_mask:0xf bank_mask:0x3
    s_nop 1
    v_mov_b32_dpp v24, v29 row_newbcast:12 row_mask:0xf bank_mask:0xc
    v_and_b32 v32, v24, v8
    v_and_b32 v33, v24, v9
    v_and_b32 v34, v24, v10
    v_and_b32 v35, v24, v11
    s_waitcnt vmcnt(7)
    s_nop 0
    v_mfma_f32_16x16x32_bf16 v[20:23], v[32:35], v[88:91], v[20:23]
    v_mov_b32_dpp v24, v29 row_newbcast:5 row_mask:0xf bank_mask:0x3
    s_nop 1
    v_mov_b32_dpp v24, v29 row_newbcast:13 row_mask:0xf bank_mask:0xc
    v_and_b32 v36, v24, v8
    v_and_b32 v37, v24, v9
    v_and_b32 v38, v24, v10
    v_and_b32 v39, v24, v11
    s_waitcnt vmcnt(6)
    s_nop 0
    v_mfma_f32_16x16x32_bf16 v[20:23], v[36:39], v[92:95], v[20:23]
    v_mov_b32_dpp v24, v29 row_newbcast:6 row_mask:0xf bank_mask:0x3
    s_nop 1
    v_mov_b32_dpp v24, v29 row_newbcast:14 row_mask:0xf bank_mask:0xc
    v_and_b32 v32, v24, v8
    v_and_b32 v33, v24, v9
    v_and_b32 v34, v24, v10
    v_and_b32 v35, v24, v11
    s_waitcnt vmcnt(5)
    s_nop 0
    v_mfma_f32_16x16x32_bf16 v[20:23], v[32:35], v[96:99], v[20:23]
    v_mov_b32_dpp v24, v29 row_newbcast:7 row_mask:0xf bank_mask:0x3
    s_nop 1
    v_mov_b32_dpp v24, v29 row_newbcast:15 row_mask:0xf bank_mask:0xc
    v_and_b32 v36, v24, v8
    v_and_b32 v37, v24, v9
    v_and_b32 v38, v24, v10
    v_and_b32 v39, v24, v11
    s_waitcnt vmcnt(4)
    s_nop 0
    v_mfma_f32_16x16x32_bf16 v[20:23], v[36:39], v[100:103], v[20:23]
    v_mov_b32_dpp v24, v30 row_newbcast:0 row_mask:0xf bank_mask:0x3
    s_nop 1
    v_mov_b32_dpp v24, v30 row_newbcast:8 row_mask:0xf bank_mask:0xc
    v_and_b32 v32, v24, v8
    v_and_b32 v33, v24, v9
    v_and_b32 v34, v24, v10
    v_and_b32 v35, v24, v11
    s_waitcnt vmcnt(3)
    s_nop 0
    v_mfma_f32_16x16x32_bf16 v[20:23], v[32:35], v[104:107], v[20:23]
    v_mov_b32_dpp v24, v30 row_newbcast:1 row_mask:0xf bank_mask:0x3
    s_nop 1
    v_mov_b32_dpp v24, v30 row_newbcast:9 row_mask:0xf bank_mask:0xc
    v_and_b32 v36, v24, v8
    v_and_b32 v37, v24, v9
    v_and_b32 v38, v24, v10
    v_and_b32 v39, v24, v11
    s_waitcnt vmcnt(2)
    s_nop 0
    v_mfma_f32_16x16x32_bf16 v[20:23], v[36:39], v[108:111], v[20:23]
    v_mov_b32_dpp v24, v30 row_newbcast:2 row_mask:0xf bank_mask:0x3
    s_nop 1
    v_mov_b32_dpp v24, v30 row_newbcast:10 row_mask:0xf bank_mask:0xc
    v_and_b32 v32, v24, v8
    v_and_b32 v33, v24, v9
    v_and_b32 v34, v24, v10
    v_and_b32 v35, v24, v11
    s_waitcnt vmcnt(1)
    s_nop 0
    v_mfma_f32_16x16x32_bf16 v[20:23], v[32:35], v[112:115], v[20:23]
    v_mov_b32_dpp v24, v30 row_newbcast:3 row_mask:0xf bank_mask:0x3
    s_nop 1
    v_mov_b32_dpp v24, v30 row_newbcast:11 row_mask:0xf bank_mask:0xc
    v_and_b32 v36, v24, v8
    v_and_b32 v37, v24, v9
    v_and_b32 v38, v24, v10
    v_and_b32 v39, v24, v11
    s_waitcnt vmcnt(0)
    s_nop 0
    v_mfma_f32_16x16x32_bf16 v[20:23], v[36:39], v[116:119], v[20:23]
    s_nop 7
    buffer_store_dwordx4 v[20:23], v5, s[28:31], s5 offen sc1
    s_lshl_b32 s56, s85, 4
    s_add_u32 s56, s56, 1298432
    s_waitcnt vmcnt(0)
    s_mov_b64 exec, 1
    buffer_store_dwordx2 v[136:137], off, s[28:31], s56 sc1
    s_mov_b64 exec, -1
L_g1done:
    v_mov_b32 v12, 0
    v_lshlrev_b32 v13, 4, v1
    s_lshl_b32 s57, s2, 9
    s_add_u32 s57, s57, 1307648
    s_add_u32 s58, s57, 262144
    v_lshrrev_b32 v15, 5, v1
    v_lshlrev_b32 v15, 17, v15
    v_and_b32 v14, 31, v1
    v_lshl_add_u32 v15, v14, 4, v15
L_sw:
    ds_read_b32 v14, v12 offset:37444
    s_waitcnt lgkmcnt(0)
    v_readfirstlane_b32 s56, v14
    s_nop 0
    s_cmp_eq_u32 s56, 8
    s_cbranch_scc1 L_swok
    s_sleep 8
    s_branch L_sw
L_swok:
    ds_read_b128 v[16:19], v13 offset:38272
    ds_read_b128 v[20:23], v13 offset:39296
    s_waitcnt lgkmcnt(0)
    buffer_store_dwordx4 v[16:19], v15, s[28:31], s57 offen sc1
    s_lshl_b32 s56, s2, 4
    s_add_u32 s56, s56, 1303552
    s_waitcnt vmcnt(0)
    s_mov_b64 exec, 1
    buffer_store_dwordx2 v[136:137], off, s[28:31], s56 sc1
    s_mov_b64 exec, -1
    v_and_b32 v12, 7, v1
    s_and_b32 s56, s2, 0xf8
    v_add_lshl_u32 v12, v12, s56, 4
    s_mov_b32 s56, 1303552
L_t4:
    buffer_load_dwordx2 v[16:17], v12, s[28:31], s56 offen sc1
    s_waitcnt vmcnt(0)
    v_cmp_ne_u64 vcc, v[16:17], v[136:137]
    s_cbranch_vccz L_t4_ok
    s_cmp_eq_u32 s61, 0
    s_cbranch_scc1 L_t4_ok
    s_sub_u32 s61, s61, 1
    s_sleep 16
    s_branch L_t4
L_t4_ok:
    v_mov_b32 v12, 0
    v_mov_b32 v13, 1
    ds_write_b32 v12, v13 offset:37448
    s_waitcnt lgkmcnt(0)
    s_cmp_ge_u32 s85, 216
    s_cbranch_scc1 L_cons
    s_cmp_lt_u32 s6, 54
    s_cbranch_scc0 L_g2done
    s_lshl_b32 s56, s6, 5
    v_add_u32 v15, s56, v7
    v_mul_u32_u24 v15, 1280, v15
    v_lshl_add_u32 v15, v6, 4, v15
    s_mov_b32 s58, 0
    buffer_load_dwordx4 v[40:43], v15, s[40:43], s58 offen offset:0 nt
    buffer_load_dwordx4 v[44:47], v15, s[40:43], s58 offen offset:256 nt
    buffer_load_dwordx4 v[48:51], v15, s[40:43], s58 offen offset:512 nt
    buffer_load_dwordx4 v[52:55], v15, s[40:43], s58 offen offset:768 nt
    buffer_load_dwordx4 v[56:59], v15, s[40:43], s58 offen offset:1024 nt
    s_mov_b32 s58, 5120
    buffer_load_dwordx4 v[60:63], v15, s[40:43], s58 offen offset:0 nt
    buffer_load_dwordx4 v[64:67], v15, s[40:43], s58 offen offset:256 nt
    buffer_load_dwordx4 v[68:71], v15, s[40:43], s58 offen offset:512 nt
    buffer_load_dwordx4 v[72:75], v15, s[40:43], s58 offen offset:768 nt
    buffer_load_dwordx4 v[76:79], v15, s[40:43], s58 offen offset:1024 nt
    s_waitcnt vmcnt(9)
    s_mov_b32 s58, 10240
    buffer_load_dwordx4 v[80:83], v15, s[40:43], s58 offen offset:0 nt
    s_waitcnt vmcnt(9)
    buffer_load_dwordx4 v[84:87], v15, s[40:43], s58 offen offset:256 nt
    s_waitcnt vmcnt(9)
    buffer_load_dwordx4 v[88:91], v15, s[40:43], s58 offen offset:512 nt
    s_waitcnt vmcnt(9)
    buffer_load_dwordx4 v[92:95], v15, s[40:43], s58 offen offset:768 nt
    s_waitcnt vmcnt(9)
    buffer_load_dwordx4 v[96:99], v15, s[40:43], s58 offen offset:1024 nt
    s_waitcnt vmcnt(9)
    s_mov_b32 s58, 15360
    buffer_load_dwordx4 v[100:103], v15, s[40:43], s58 offen offset:0 nt
    s_waitcnt vmcnt(9)
    buffer_load_dwordx4 v[104:107], v15, s[40:43], s58 offen offset:256 nt
    s_waitcnt vmcnt(9)
    buffer_load_dwordx4 v[108:111], v15, s[40:43], s58 offen offset:512 nt
    s_waitcnt vmcnt(9)
    buffer_load_dwordx4 v[112:115], v15, s[40:43], s58 offen offset:768 nt
    s_waitcnt vmcnt(9)
    buffer_load_dwordx4 v[116:119], v15, s[40:43], s58 offen offset:1024 nt
    s_lshr_b32 s56, s6, 1
    s_lshl_b32 s56, s56, 7
    v_and_b32 v12, 7, v1
    v_lshlrev_b32 v12, 4, v12
    v_add_u32 v12, s56, v12
    s_mov_b32 s56, 1298432
L_t1:
    buffer_load_dwordx2 v[16:17], v12, s[28:31], s56 offen sc1
    s_waitcnt vmcnt(0)
    v_cmp_ne_u64 vcc, v[16:17], v[136:137]
    s_cbranch_vccz L_t1_ok
    s_cmp_eq_u32 s61, 0
    s_cbranch_scc1 L_t1_ok
    s_sub_u32 s61, s61, 1
    s_sleep 32
    s_branch L_t1
L_t1_ok:
    s_lshl_b32 s56, s6, 12
    s_add_u32 s56, s56, 450560
    v_lshlrev_b32 v12, 4, v1
    buffer_load_dwordx4 v[16:19], v12, s[28:31], s56 offen sc1
    buffer_load_dwordx4 v[20:23], v12, s[28:31], s56 offen offset:1024 sc1
    buffer_load_dwordx4 v[24:27], v12, s[28:31], s56 offen offset:2048 sc1
    buffer_load_dwordx4 v[28:31], v12, s[28:31], s56 offen offset:3072 sc1
    v_bfe_u32 v12, v6, 1, 1
    v_lshlrev_b32 v12, 7, v12
    v_bfe_u32 v13, v6, 2, 1
    v_lshl_add_u32 v12, v13, 3, v12
    v_and_b32 v13, 1, v6
    v_lshl_add_u32 v12, v13, 2, v12
    v_lshrrev_b32 v13, 3, v6
    v_lshlrev_b32 v13, 7, v13
    v_lshl_add_u32 v13, v7, 5, v13
    s_waitcnt vmcnt(0)
    v_add_f32 v16, v16, v20
    v_add_f32 v17, v17, v21
    v_add_f32 v18, v18, v22
    v_add_f32 v19, v19, v23
    v_mov_b32 v20, v16
    v_mov_b32 v21, v17
    v_mov_b32 v22, v18
    v_mov_b32 v23, v19
    v_permlane16_swap_b32 v16, v20
    v_permlane16_swap_b32 v17, v21
    v_permlane16_swap_b32 v18, v22
    v_permlane16_swap_b32 v19, v23
    v_add_f32 v16, v16, v20
    v_add_f32 v17, v17, v21
    v_add_f32 v18, v18, v22
    v_add_f32 v19, v19, v23
    v_mov_b32 v20, v16
    v_mov_b32 v21, v17
    v_mov_b32 v22, v18
    v_mov_b32 v23, v19
    v_permlane32_swap_b32 v16, v20
    v_permlane32_swap_b32 v17, v21
    v_permlane32_swap_b32 v18, v22
    v_permlane32_swap_b32 v19, v23
    v_add_f32 v16, v16, v20
    v_add_f32 v17, v17, v21
    v_add_f32 v18, v18, v22
    v_add_f32 v19, v19, v23
    v_cvt_pk_bf16_f32 v16, v16, v16
    v_and_b32 v16, 0xffff0000, v16
    v_cvt_pk_bf16_f32 v17, v17, v17
    v_and_b32 v17, 0xffff0000, v17
    v_cvt_pk_bf16_f32 v18, v18, v18
    v_and_b32 v18, 0xffff0000, v18
    v_cvt_pk_bf16_f32 v19, v19, v19
    v_and_b32 v19, 0xffff0000, v19
    v_mul_f32_dpp v20, v16, v16 row_ror:8 row_mask:0xf bank_mask:0xf
    v_mul_f32_dpp v21, v17, v17 row_ror:8 row_mask:0xf bank_mask:0xf
    v_mul_f32_dpp v22, v18, v18 row_ror:8 row_mask:0xf bank_mask:0xf
    v_mul_f32_dpp v23, v19, v19 row_ror:8 row_mask:0xf bank_mask:0xf
    v_cvt_pk_bf16_f32 v20, v20, v20
    v_cvt_pk_bf16_f32 v21, v21, v21
    v_cvt_pk_bf16_f32 v22, v22, v22
    v_cvt_pk_bf16_f32 v23, v23, v23
    ds_write_b32 v12, v20 offset:37504
    ds_write_b32 v12, v21 offset:37536
    ds_write_b32 v12, v22 offset:37568
    ds_write_b32 v12, v23 offset:37600
    v_add_f32 v24, v24, v28
    v_add_f32 v25, v25, v29
    v_add_f32 v26, v26, v30
    v_add_f32 v27, v27, v31
    v_mov_b32 v28, v24
    v_mov_b32 v29, v25
    v_mov_b32 v30, v26
    v_mov_b32 v31, v27
    v_permlane16_swap_b32 v24, v28
    v_permlane16_swap_b32 v25, v29
    v_permlane16_swap_b32 v26, v30
    v_permlane16_swap_b32 v27, v31
    v_add_f32 v24, v24, v28
    v_add_f32 v25, v25, v29
    v_add_f32 v26, v26, v30
    v_add_f32 v27, v27, v31
    v_mov_b32 v28, v24
    v_mov_b32 v29, v25
    v_mov_b32 v30, v26
    v_mov_b32 v31, v27
    v_permlane32_swap_b32 v24, v28
    v_permlane32_swap_b32 v25, v29
    v_permlane32_swap_b32 v26, v30
    v_permlane32_swap_b32 v27, v31
    v_add_f32 v24, v24, v28
    v_add_f32 v25, v25, v29
    v_add_f32 v26, v26, v30
    v_add_f32 v27, v27, v31
    v_cvt_pk_bf16_f32 v24, v24, v24
    v_and_b32 v24, 0xffff0000, v24
    v_cvt_pk_bf16_f32 v25, v25, v25
    v_and_b32 v25, 0xffff0000, v25
    v_cvt_pk_bf16_f32 v26, v26, v26
    v_and_b32 v26, 0xffff0000, v26
    v_cvt_pk_bf16_f32 v27, v27, v27
    v_and_b32 v27, 0xffff0000, v27
    v_mul_f32_dpp v28, v24, v24 row_ror:8 row_mask:0xf bank_mask:0xf
    v_mul_f32_dpp v29, v25, v25 row_ror:8 row_mask:0xf bank_mask:0xf
    v_mul_f32_dpp v30, v26, v26 row_ror:8 row_mask:0xf bank_mask:0xf
    v_mul_f32_dpp v31, v27, v27 row_ror:8 row_mask:0xf bank_mask:0xf
    v_cvt_pk_bf16_f32 v28, v28, v28
    v_cvt_pk_bf16_f32 v29, v29, v29
    v_cvt_pk_bf16_f32 v30, v30, v30
    v_cvt_pk_bf16_f32 v31, v31, v31
    ds_write_b32 v12, v28 offset:37520
    ds_write_b32 v12, v29 offset:37552
    ds_write_b32 v12, v30 offset:37584
    ds_write_b32 v12, v31 offset:37616
    s_waitcnt lgkmcnt(0)
    ds_read_b128 v[16:19], v13 offset:37504
    ds_read_b128 v[20:23], v13 offset:37520
    s_waitcnt lgkmcnt(0)
    v_and_b32 v32, v16, v8
    v_and_b32 v33, v16, v9
    v_and_b32 v34, v16, v10
    v_and_b32 v35, v16, v11
    s_nop 1
    v_mfma_f32_16x16x32_bf16 v[140:143], v[32:35], v[40:43], 0
    s_mov_b32 s58, 20480
    buffer_load_dwordx4 v[40:43], v15, s[40:43], s58 offen offset:0 nt
    v_mfma_f32_16x16x32_bf16 v[144:147], v[32:35], v[44:47], 0
    buffer_load_dwordx4 v[44:47], v15, s[40:43], s58 offen offset:256 nt
    v_mfma_f32_16x16x32_bf16 v[148:151], v[32:35], v[48:51], 0
    buffer_load_dwordx4 v[48:51], v15, s[40:43], s58 offen offset:512 nt
    v_mfma_f32_16x16x32_bf16 v[152:155], v[32:35], v[52:55], 0
    buffer_load_dwordx4 v[52:55], v15, s[40:43], s58 offen offset:768 nt
    v_mfma_f32_16x16x32_bf16 v[156:159], v[32:35], v[56:59], 0
    buffer_load_dwordx4 v[56:59], v15, s[40:43], s58 offen offset:1024 nt
    v_and_b32 v36, v17, v8
    v_and_b32 v37, v17, v9
    v_and_b32 v38, v17, v10
    v_and_b32 v39, v17, v11
    s_nop 1
    v_mfma_f32_16x16x32_bf16 v[140:143], v[36:39], v[60:63], v[140:143]
    s_mov_b32 s58, 25600
    buffer_load_dwordx4 v[60:63], v15, s[40:43], s58 offen offset:0 nt
    v_mfma_f32_16x16x32_bf16 v[144:147], v[36:39], v[64:67], v[144:147]
    buffer_load_dwordx4 v[64:67], v15, s[40:43], s58 offen offset:256 nt
    v_mfma_f32_16x16x32_bf16 v[148:151], v[36:39], v[68:71], v[148:151]
    buffer_load_dwordx4 v[68:71], v15, s[40:43], s58 offen offset:512 nt
    v_mfma_f32_16x16x32_bf16 v[152:155], v[36:39], v[72:75], v[152:155]
    buffer_load_dwordx4 v[72:75], v15, s[40:43], s58 offen offset:768 nt
    v_mfma_f32_16x16x32_bf16 v[156:159], v[36:39], v[76:79], v[156:159]
    buffer_load_dwordx4 v[76:79], v15, s[40:43], s58 offen offset:1024 nt
    v_and_b32 v32, v18, v8
    v_and_b32 v33, v18, v9
    v_and_b32 v34, v18, v10
    v_and_b32 v35, v18, v11
    s_nop 1
    v_mfma_f32_16x16x32_bf16 v[140:143], v[32:35], v[80:83], v[140:143]
    v_mfma_f32_16x16x32_bf16 v[144:147], v[32:35], v[84:87], v[144:147]
    v_mfma_f32_16x16x32_bf16 v[148:151], v[32:35], v[88:91], v[148:151]
    v_mfma_f32_16x16x32_bf16 v[152:155], v[32:35], v[92:95], v[152:155]
    v_mfma_f32_16x16x32_bf16 v[156:159], v[32:35], v[96:99], v[156:159]
    v_and_b32 v36, v19, v8
    v_and_b32 v37, v19, v9
    v_and_b32 v38, v19, v10
    v_and_b32 v39, v19, v11
    s_nop 1
    v_mfma_f32_16x16x32_bf16 v[140:143], v[36:39], v[100:103], v[140:143]
    v_mfma_f32_16x16x32_bf16 v[144:147], v[36:39], v[104:107], v[144:147]
    v_mfma_f32_16x16x32_bf16 v[148:151], v[36:39], v[108:111], v[148:151]
    v_mfma_f32_16x16x32_bf16 v[152:155], v[36:39], v[112:115], v[152:155]
    v_mfma_f32_16x16x32_bf16 v[156:159], v[36:39], v[116:119], v[156:159]
    v_and_b32 v32, v20, v8
    v_and_b32 v33, v20, v9
    v_and_b32 v34, v20, v10
    v_and_b32 v35, v20, v11
    s_waitcnt vmcnt(9)
    s_nop 0
    v_mfma_f32_16x16x32_bf16 v[140:143], v[32:35], v[40:43], v[140:143]
    s_mov_b32 s58, 30720
    buffer_load_dwordx4 v[80:83], v15, s[40:43], s58 offen offset:0 nt
    s_waitcnt vmcnt(9)
    v_mfma_f32_16x16x32_bf16 v[144:147], v[32:35], v[44:47], v[144:147]
    buffer_load_dwordx4 v[84:87], v15, s[40:43], s58 offen offset:256 nt
    s_waitcnt vmcnt(9)
    v_mfma_f32_16x16x32_bf16 v[148:151], v[32:35], v[48:51], v[148:151]
    buffer_load_dwordx4 v[88:91], v15, s[40:43], s58 offen offset:512 nt
    s_waitcnt vmcnt(9)
    v_mfma_f32_16x16x32_bf16 v[152:155], v[32:35], v[52:55], v[152:155]
    buffer_load_dwordx4 v[92:95], v15, s[40:43], s58 offen offset:768 nt
    s_waitcnt vmcnt(9)
    v_mfma_f32_16x16x32_bf16 v[156:159], v[32:35], v[56:59], v[156:159]
    buffer_load_dwordx4 v[96:99], v15, s[40:43], s58 offen offset:1024 nt
    v_and_b32 v36, v21, v8
    v_and_b32 v37, v21, v9
    v_and_b32 v38, v21, v10
    v_and_b32 v39, v21, v11
    s_waitcnt vmcnt(9)
    s_nop 0
    v_mfma_f32_16x16x32_bf16 v[140:143], v[36:39], v[60:63], v[140:143]
    s_mov_b32 s58, 35840
    buffer_load_dwordx4 v[100:103], v15, s[40:43], s58 offen offset:0 nt
    s_waitcnt vmcnt(9)
    v_mfma_f32_16x16x32_bf16 v[144:147], v[36:39], v[64:67], v[144:147]
    buffer_load_dwordx4 v[104:107], v15, s[40:43], s58 offen offset:256 nt
    s_waitcnt vmcnt(9)
    v_mfma_f32_16x16x32_bf16 v[148:151], v[36:39], v[68:71], v[148:151]
    buffer_load_dwordx4 v[108:111], v15, s[40:43], s58 offen offset:512 nt
    s_waitcnt vmcnt(9)
    v_mfma_f32_16x16x32_bf16 v[152:155], v[36:39], v[72:75], v[152:155]
    buffer_load_dwordx4 v[112:115], v15, s[40:43], s58 offen offset:768 nt
    s_waitcnt vmcnt(9)
    v_mfma_f32_16x16x32_bf16 v[156:159], v[36:39], v[76:79], v[156:159]
    buffer_load_dwordx4 v[116:119], v15, s[40:43], s58 offen offset:1024 nt
    v_and_b32 v32, v22, v8
    v_and_b32 v33, v22, v9
    v_and_b32 v34, v22, v10
    v_and_b32 v35, v22, v11
    s_waitcnt vmcnt(9)
    s_nop 0
    v_mfma_f32_16x16x32_bf16 v[140:143], v[32:35], v[80:83], v[140:143]
    s_waitcnt vmcnt(8)
    v_mfma_f32_16x16x32_bf16 v[144:147], v[32:35], v[84:87], v[144:147]
    s_waitcnt vmcnt(7)
    v_mfma_f32_16x16x32_bf16 v[148:151], v[32:35], v[88:91], v[148:151]
    s_waitcnt vmcnt(6)
    v_mfma_f32_16x16x32_bf16 v[152:155], v[32:35], v[92:95], v[152:155]
    s_waitcnt vmcnt(5)
    v_mfma_f32_16x16x32_bf16 v[156:159], v[32:35], v[96:99], v[156:159]
    v_and_b32 v36, v23, v8
    v_and_b32 v37, v23, v9
    v_and_b32 v38, v23, v10
    v_and_b32 v39, v23, v11
    s_waitcnt vmcnt(4)
    s_nop 0
    v_mfma_f32_16x16x32_bf16 v[140:143], v[36:39], v[100:103], v[140:143]
    s_waitcnt vmcnt(3)
    v_mfma_f32_16x16x32_bf16 v[144:147], v[36:39], v[104:107], v[144:147]
    s_waitcnt vmcnt(2)
    v_mfma_f32_16x16x32_bf16 v[148:151], v[36:39], v[108:111], v[148:151]
    s_waitcnt vmcnt(1)
    v_mfma_f32_16x16x32_bf16 v[152:155], v[36:39], v[112:115], v[152:155]
    s_waitcnt vmcnt(0)
    v_mfma_f32_16x16x32_bf16 v[156:159], v[36:39], v[116:119], v[156:159]
    buffer_store_dwordx4 v[140:143], v4, s[28:31], s7 offen sc1
    s_add_u32 s7, s7, 57344
    buffer_store_dwordx4 v[144:147], v4, s[28:31], s7 offen sc1
    s_add_u32 s7, s7, 57344
    buffer_store_dwordx4 v[148:151], v4, s[28:31], s7 offen sc1
    s_add_u32 s7, s7, 57344
    buffer_store_dwordx4 v[152:155], v4, s[28:31], s7 offen sc1
    s_add_u32 s7, s7, 57344
    buffer_store_dwordx4 v[156:159], v4, s[28:31], s7 offen sc1
    s_lshl_b32 s56, s6, 4
    s_add_u32 s56, s56, 1302528
    s_waitcnt vmcnt(0)
    s_mov_b64 exec, 1
    buffer_store_dwordx2 v[136:137], off, s[28:31], s56 sc1
    s_mov_b64 exec, -1
    s_endpgm
L_g2done:
    s_cmp_eq_u32 s86, 1
    s_cbranch_scc0 L_end
    v_and_b32 v12, 7, v1
    s_lshl_b32 s56, s87, 3
    v_add_lshl_u32 v12, v12, s56, 4
    s_mov_b32 s56, 1294336
L_t2:
    buffer_load_dwordx2 v[16:17], v12, s[28:31], s56 offen sc1
    s_waitcnt vmcnt(0)
    v_cmp_ne_u64 vcc, v[16:17], v[136:137]
    s_cbranch_vccz L_t2_ok
    s_cmp_eq_u32 s61, 0
    s_cbranch_scc1 L_t2_ok
    s_sub_u32 s61, s61, 1
    s_sleep 32
    s_branch L_t2
L_t2_ok:
    s_lshl_b32 s56, s87, 7
    v_add_u32 v3, s56, v7
    v_mul_u32_u24 v3, 1280, v3
    v_lshl_add_u32 v3, v6, 4, v3
    s_lshl_b32 s56, s88, 8
    v_add_u32 v3, s56, v3
    s_mov_b32 s56, 0
    s_mov_b32 s57, 0
    s_mov_b32 s58, 0
L_wo:
    s_mov_b32 m0, s56
    s_add_u32 s56, s56, 1024
    buffer_load_dwordx4 v3, s[20:23], s57 offen nt lds
    s_add_u32 s57, s57, 5120
    s_waitcnt vmcnt(9)
    s_add_u32 s58, s58, 1
    s_cmp_lt_u32 s58, 32
    s_cbranch_scc1 L_wo
    s_waitcnt vmcnt(0)
    v_mov_b32 v12, 0
    v_lshlrev_b32 v14, 7, v1
    s_mul_i32 s57, s87, 9216
    s_add_u32 s57, s57, 933888
    s_add_u32 s58, s57, 8192
L_ww:
    ds_read_b32 v13, v12 offset:37452
    s_waitcnt lgkmcnt(0)
    v_readfirstlane_b32 s56, v13
    s_nop 0
    s_cmp_ge_u32 s56, 64
    s_cbranch_scc1 L_wwok
    s_sleep 8
    s_branch L_ww
L_wwok:
    buffer_load_dword v13, v14, s[28:31], s57 offen sc1
    s_mov_b64 exec, 0xff
    buffer_load_dword v15, v14, s[28:31], s58 offen sc1
    s_waitcnt vmcnt(0)
    s_mov_b64 exec, -1
    s_endpgm
L_cons:
    s_sub_u32 s6, s85, 216
    v_and_b32 v2, 3, v1
    v_lshlrev_b32 v2, 2, v2
    v_and_b32 v3, 1, v7
    v_lshl_add_u32 v2, v3, 1, v2
    v_lshrrev_b32 v3, 1, v7
    v_add_u32 v2, v2, v3
    v_lshlrev_b32 v2, 1, v2
    s_lshl_b32 s56, s6, 5
    v_add_u32 v2, s56, v2
    v_bfe_u32 v3, v1, 2, 1
    v_mul_u32_u24 v3, 1280, v3
    v_add_u32 v2, v2, v3
    buffer_load_ushort v3, v2, s[24:27], 0 offen
    v_lshlrev_b32 v4, 4, v1
    v_add_u32 v5, 4096, v4
    s_mul_i32 s54, s6, 7168
    s_add_u32 s54, s54, 163840
    s_lshl_b32 s53, s6, 12
    s_lshr_b32 s56, s6, 3
    v_bfe_u32 v12, v1, 3, 2
    v_mul_u32_u24 v12, 5, v12
    v_add_u32 v12, s56, v12
    v_and_b32 v13, 7, v1
    v_lshlrev_b32 v14, 8, v13
    v_sub_u32 v12, v12, v14
    v_and_b32 v14, 0, v13
    v_sub_u32 v12, v12, v14
    v_and_b32 v12, 31, v12
    v_lshlrev_b32 v12, 3, v12
    v_add_lshl_u32 v12, v12, v13, 4
    v_min_u32 v13, 53, v1
    v_lshlrev_b32 v13, 4, v13
    v_add_u32 v13, 8192, v13
    v_mov_b32 v14, 0
L_cw:
    ds_read_b32 v15, v14 offset:37440
    s_waitcnt lgkmcnt(0)
    v_readfirstlane_b32 s56, v15
    s_nop 0
    s_cmp_lg_u32 s56, 0
    s_cbranch_scc1 L_cwok
    s_sleep 32
    s_branch L_cw
L_cwok:
    s_mov_b32 s56, 1294336
L_t3:
    buffer_load_dwordx2 v[16:17], v12, s[28:31], s56 offen sc1
    buffer_load_dwordx2 v[18:19], v13, s[28:31], s56 offen sc1
    s_waitcnt vmcnt(0)
    v_cmp_ne_u64 vcc, v[16:17], v[136:137]
    v_cmp_ne_u64 s[58:59], v[18:19], v[136:137]
    s_nop 0
    s_or_b64 vcc, vcc, s[58:59]
    s_cbranch_scc0 L_t3_ok
    s_cmp_eq_u32 s61, 0
    s_cbranch_scc1 L_t3_ok
    s_sub_u32 s61, s61, 1
    s_sleep 32
    s_branch L_t3
L_t3_ok:
    v_mov_b32 v72, 0
    v_mov_b32 v73, 0
    v_mov_b32 v74, 0
    v_mov_b32 v75, 0
    buffer_load_dwordx4 v[48:51], v4, s[28:31], s54 offen offset:0 sc1
    buffer_load_dwordx4 v[52:55], v4, s[28:31], s54 offen offset:1024 sc1
    buffer_load_dwordx4 v[56:59], v4, s[28:31], s54 offen offset:2048 sc1
    buffer_load_dwordx4 v[60:63], v4, s[28:31], s54 offen offset:3072 sc1
    buffer_load_dwordx4 v[64:67], v5, s[28:31], s54 offen offset:0 sc1
    buffer_load_dwordx4 v[68:71], v5, s[28:31], s54 offen offset:1024 sc1
    s_mov_b32 exec_hi, 0xffff
    buffer_load_dwordx4 v[72:75], v5, s[28:31], s54 offen offset:2048 sc1
    s_mov_b64 exec, -1
    s_waitcnt vmcnt(0)
    v_add_f32 v8, v48, v52
    v_add_f32 v9, v49, v53
    v_add_f32 v10, v50, v54
    v_add_f32 v11, v51, v55
    v_add_f32 v8, v8, v56
    v_add_f32 v9, v9, v57
    v_add_f32 v10, v10, v58
    v_add_f32 v11, v11, v59
    v_add_f32 v8, v8, v60
    v_add_f32 v9, v9, v61
    v_add_f32 v10, v10, v62
    v_add_f32 v11, v11, v63
    v_add_f32 v8, v8, v64
    v_add_f32 v9, v9, v65
    v_add_f32 v10, v10, v66
    v_add_f32 v11, v11, v67
    v_add_f32 v8, v8, v68
    v_add_f32 v9, v9, v69
    v_add_f32 v10, v10, v70
    v_add_f32 v11, v11, v71
    v_add_f32 v8, v8, v72
    v_add_f32 v9, v9, v73
    v_add_f32 v10, v10, v74
    v_add_f32 v11, v11, v75
    v_permlane32_swap_b32 v8, v9
    s_nop 0
    v_permlane32_swap_b32 v10, v11
    v_add_f32 v8, v8, v9
    v_add_f32 v10, v10, v11
    s_nop 1
    v_permlane16_swap_b32 v8, v10
    v_add_f32 v8, v8, v10
    s_nop 1
    v_add_f32_dpp v8, v8, v8 row_ror:8 row_mask:0xf bank_mask:0xf
    v_cvt_pk_bf16_f32 v8, v8, v8
    v_and_b32 v8, 0xffff0000, v8
    v_mul_f32 v9, 0xbfb8aa3b, v8
    v_exp_f32 v9, v9
    s_nop 0
    v_add_f32 v9, 1.0, v9
    v_rcp_f32 v10, v9
    s_nop 0
    v_mul_f32 v11, v8, v10
    v_fma_f32 v12, -v11, v9, v8
    v_fma_f32 v12, v12, v10, v11
    v_mov_b32 v13, 0x1f8
    v_cmp_class_f32 vcc, v12, v13
    s_nop 1
    v_cndmask_b32 v11, v11, v12, vcc
    v_cvt_pk_bf16_f32 v6, v11, v11
    v_and_b32 v6, 0xffff0000, v6
    v_lshlrev_b32 v3, 16, v3
    s_barrier
    buffer_load_dwordx4 v[16:19], v4, s[28:31], s53 offen offset:0 sc1
    buffer_load_dwordx4 v[20:23], v4, s[28:31], s53 offen offset:1024 sc1
    buffer_load_dwordx4 v[24:27], v4, s[28:31], s53 offen offset:2048 sc1
    buffer_load_dwordx4 v[28:31], v4, s[28:31], s53 offen offset:3072 sc1
    s_sleep 2
    buffer_load_dwordx4 v[32:35], v4, s[28:31], s53 offen offset:0 sc1
    buffer_load_dwordx4 v[36:39], v4, s[28:31], s53 offen offset:1024 sc1
    buffer_load_dwordx4 v[40:43], v4, s[28:31], s53 offen offset:2048 sc1
    buffer_load_dwordx4 v[44:47], v4, s[28:31], s53 offen offset:3072 sc1
L_p0:
    s_waitcnt vmcnt(4)
    v_max3_u32 v12, v16, v18, v20
    v_pk_add_f32 v[8:9], v[16:17], v[20:21]
    v_max3_u32 v13, v22, v24, v26
    v_pk_add_f32 v[10:11], v[18:19], v[22:23]
    v_max3_u32 v12, v12, v28, v30
    v_pk_add_f32 v[14:15], v[24:25], v[28:29]
    v_max_u32 v12, v12, v13
    v_pk_add_f32 v[100:101], v[26:27], v[30:31]
    v_cmp_eq_u32 vcc, -1, v12
    v_pk_add_f32 v[8:9], v[8:9], v[14:15]
    v_pk_add_f32 v[10:11], v[10:11], v[100:101]
    s_cbranch_vccz L_p2
    buffer_load_dwordx4 v[16:19], v4, s[28:31], s53 offen offset:0 sc1
    buffer_load_dwordx4 v[20:23], v4, s[28:31], s53 offen offset:1024 sc1
    buffer_load_dwordx4 v[24:27], v4, s[28:31], s53 offen offset:2048 sc1
    buffer_load_dwordx4 v[28:31], v4, s[28:31], s53 offen offset:3072 sc1
    s_waitcnt vmcnt(4)
    v_max3_u32 v12, v32, v34, v36
    v_pk_add_f32 v[8:9], v[32:33], v[36:37]
    v_max3_u32 v13, v38, v40, v42
    v_pk_add_f32 v[10:11], v[34:35], v[38:39]
    v_max3_u32 v12, v12, v44, v46
    v_pk_add_f32 v[14:15], v[40:41], v[44:45]
    v_max_u32 v12, v12, v13
    v_pk_add_f32 v[100:101], v[42:43], v[46:47]
    v_cmp_eq_u32 vcc, -1, v12
    v_pk_add_f32 v[8:9], v[8:9], v[14:15]
    v_pk_add_f32 v[10:11], v[10:11], v[100:101]
    s_cbranch_vccz L_p2
    buffer_load_dwordx4 v[32:35], v4, s[28:31], s53 offen offset:0 sc1
    buffer_load_dwordx4 v[36:39], v4, s[28:31], s53 offen offset:1024 sc1
    buffer_load_dwordx4 v[40:43], v4, s[28:31], s53 offen offset:2048 sc1
    buffer_load_dwordx4 v[44:47], v4, s[28:31], s53 offen offset:3072 sc1
    s_cmp_eq_u32 s61, 0
    s_cbranch_scc1 L_p2
    s_sub_u32 s61, s61, 1
    s_branch L_p0
L_p2:
    s_nop 0
    v_permlane32_swap_b32 v8, v9
    v_permlane32_swap_b32 v10, v11
    v_add_f32 v8, v8, v9
    v_add_f32 v10, v10, v11
    s_nop 1
    v_permlane16_swap_b32 v8, v10
    v_add_f32 v8, v8, v10
    s_nop 1
    v_add_f32_dpp v8, v8, v8 row_ror:8 row_mask:0xf bank_mask:0xf
    v_cvt_pk_bf16_f32 v8, v8, v8
    v_and_b32 v8, 0xffff0000, v8
    v_mul_f32 v8, v8, v6
    v_cvt_pk_bf16_f32 v8, v8, v8
    v_and_b32 v8, 0xffff0000, v8
    v_add_f32 v8, v8, v3
    v_cvt_pk_bf16_f32 v8, v8, v8
    s_mov_b32 exec_lo, 0x00ff00ff
    s_mov_b32 exec_hi, 0x00ff00ff
    buffer_store_short v8, v2, s[36:39], 0 offen
    s_mov_b64 exec, -1
    s_endpgm
L_main2:
    s_barrier
    v_and_b32 v24, 1, v6
    v_mov_b32 v25, 0xffff
    v_lshlrev_b32 v24, 4, v24
    v_lshlrev_b32 v25, v24, v25
    v_lshrrev_b32 v24, 1, v6
    v_cmp_eq_u32 vcc, 0, v24
    s_nop 1
    v_cndmask_b32 v8, 0, v25, vcc
    v_cmp_eq_u32 vcc, 1, v24
    s_nop 1
    v_cndmask_b32 v9, 0, v25, vcc
    v_cmp_eq_u32 vcc, 2, v24
    s_nop 1
    v_cndmask_b32 v10, 0, v25, vcc
    v_cmp_eq_u32 vcc, 3, v24
    s_nop 1
    v_cndmask_b32 v11, 0, v25, vcc
    s_mov_b32 s4, 0xcccccccc
    s_mov_b32 s5, 0xcccccccc
    s_mov_b32 s6, 0xaaaaaaaa
    s_mov_b32 s7, 0xaaaaaaaa
    s_lshl_b32 s56, s89, 9
    v_lshlrev_b32 v5, 5, v6
    v_lshl_add_u32 v5, v7, 4, v5
    v_add_u32 v5, s56, v5
    s_lshl_b32 s56, s51, 8
    v_lshlrev_b32 v3, 4, v6
    v_add_u32 v3, s56, v3
    s_lshl_b32 s62, s49, 10
    s_add_u32 s62, s62, 1228800
    s_lshl_b32 s56, s89, 7
    v_lshlrev_b32 v4, 3, v6
    v_lshl_add_u32 v4, v7, 1, v4
    v_add_u32 v4, s56, v4
    v_lshrrev_b32 v162, 2, v6
    v_lshlrev_b32 v162, 3, v162
    v_lshl_add_u32 v162, v7, 1, v162
    s_lshl_b32 s63, s49, 12
    s_add_u32 s63, s63, 1307648
    v_mov_b32 v163, 0
    v_and_b32 v24, 31, v1
    v_lshrrev_b32 v25, 5, v1
    v_lshlrev_b32 v152, 11, v25
    v_lshl_add_u32 v152, v24, 4, v152
    v_lshlrev_b32 v153, 5, v25
    v_lshlrev_b32 v154, 4, v1
    s_mul_i32 s40, s2, 1152
    s_add_u32 s40, s40, 933888
    v_lshrrev_b32 v155, 2, v6
    v_lshl_add_u32 v155, v7, 3, v155
    v_lshlrev_b32 v155, 8, v155
    v_and_b32 v24, 3, v6
    v_lshl_add_u32 v155, v24, 3, v155
    s_lshl_b32 s56, s3, 5
    v_add_u32 v155, s56, v155
    v_lshrrev_b32 v24, 3, v6
    v_and_b32 v25, 7, v6
    v_mul_u32_u24 v156, 1152, v25
    v_lshl_add_u32 v156, v24, 3, v156
    v_lshlrev_b32 v157, 9, v24
    v_bfe_u32 v25, v6, 1, 2
    v_lshl_add_u32 v157, v25, 7, v157
    v_and_b32 v26, 1, v6
    v_lshl_add_u32 v157, v26, 4, v157
    v_lshl_add_u32 v157, v7, 5, v157
    v_lshrrev_b32 v158, 1, v157
    v_lshlrev_b32 v159, 8, v26
    v_lshl_add_u32 v159, v7, 4, v159
    v_lshlrev_b32 v160, 6, v26
    v_lshl_add_u32 v160, v7, 4, v160
    s_mul_i32 s42, s87, 9216
    s_add_u32 s42, s42, 933888
    s_lshl_b32 s44, s88, 3
    s_add_u32 s44, s44, s3
    s_lshl_b32 s44, s44, 12
    s_lshl_b32 s56, s87, 7
    s_add_u32 s44, s44, s56
    s_lshl_b32 s56, s89, 3
    v_mov_b32 v161, s56
    s_mov_b32 s61, 100000
    s_waitcnt vmcnt(2)
    buffer_load_dwordx4 v[92:95], v2, s[8:11], s57 offen offset:3072 nt
    s_waitcnt vmcnt(2)
    s_add_u32 s57, s55, 1703936
    buffer_load_dwordx4 v[96:99], v2, s[8:11], s57 offen offset:0 nt
    s_waitcnt vmcnt(2)
    buffer_load_dwordx4 v[100:103], v2, s[8:11], s57 offen offset:1024 nt
    s_waitcnt vmcnt(2)
    buffer_load_dwordx4 v[104:107], v2, s[8:11], s57 offen offset:2048 nt
    s_waitcnt vmcnt(2)
    buffer_load_dwordx4 v[108:111], v2, s[8:11], s57 offen offset:3072 nt
    s_waitcnt vmcnt(2)
    s_add_u32 s57, s55, 1835008
    buffer_load_dwordx4 v[112:115], v2, s[8:11], s57 offen offset:0 nt
    s_waitcnt vmcnt(2)
    buffer_load_dwordx4 v[116:119], v2, s[8:11], s57 offen offset:1024 nt
    s_waitcnt vmcnt(2)
    buffer_load_dwordx4 v[120:123], v2, s[8:11], s57 offen offset:2048 nt
    s_waitcnt vmcnt(2)
    buffer_load_dwordx4 v[124:127], v2, s[8:11], s57 offen offset:3072 nt
    s_waitcnt vmcnt(2)
    s_add_u32 s57, s55, 1966080
    buffer_load_dwordx4 v[128:131], v2, s[8:11], s57 offen offset:0 nt
    s_waitcnt vmcnt(2)
    buffer_load_dwordx4 v[132:135], v2, s[8:11], s57 offen offset:1024 nt
    s_waitcnt vmcnt(2)
    buffer_load_dwordx4 v[136:139], v2, s[8:11], s57 offen offset:2048 nt
    s_waitcnt vmcnt(2)
    buffer_load_dwordx4 v[140:143], v2, s[8:11], s57 offen offset:3072 nt
    s_waitcnt vmcnt(2)
    s_add_u32 s57, s55, 0
    buffer_load_dwordx4 v[144:147], v2, s[8:11], s57 offen offset:0 nt
    s_waitcnt vmcnt(2)
    buffer_load_dwordx4 v[148:151], v2, s[8:11], s57 offen offset:1024 nt
    s_waitcnt vmcnt(2)
    buffer_load_dwordx4 v[76:79], v2, s[8:11], s57 offen offset:2048 nt
    s_waitcnt vmcnt(2)
    buffer_load_dwordx4 v[72:75], v2, s[8:11], s57 offen offset:3072 nt
    s_waitcnt vmcnt(2)
    s_add_u32 s57, s55, 131072
    buffer_load_dwordx4 v[68:71], v2, s[8:11], s57 offen offset:0 nt
    s_waitcnt vmcnt(2)
    buffer_load_dwordx4 v[64:67], v2, s[8:11], s57 offen offset:1024 nt
L_qf:
    ds_read_b32 v32, v163 offset:37456
    ds_read_b128 v[12:15], v3 offset:36928
    s_waitcnt lgkmcnt(0)
    v_readfirstlane_b32 s56, v32
    s_nop 0
    s_cmp_eq_u32 s56, 0
    s_cbranch_scc1 L_qf
    v_dot2_f32_bf16 v32, v80, v12, 0
    v_dot2_f32_bf16 v32, v81, v13, v32
    v_dot2_f32_bf16 v32, v82, v14, v32
    v_dot2_f32_bf16 v32, v83, v15, v32
    v_dot2_f32_bf16 v33, v84, v12, 0
    v_dot2_f32_bf16 v33, v85, v13, v33
    v_dot2_f32_bf16 v33, v86, v14, v33
    v_dot2_f32_bf16 v33, v87, v15, v33
    v_dot2_f32_bf16 v34, v88, v12, 0
    v_dot2_f32_bf16 v34, v89, v13, v34
    v_dot2_f32_bf16 v34, v90, v14, v34
    v_dot2_f32_bf16 v34, v91, v15, v34
    v_dot2_f32_bf16 v35, v92, v12, 0
    v_dot2_f32_bf16 v35, v93, v13, v35
    v_dot2_f32_bf16 v35, v94, v14, v35
    v_dot2_f32_bf16 v35, v95, v15, v35
    v_dot2_f32_bf16 v36, v96, v12, 0
    v_dot2_f32_bf16 v36, v97, v13, v36
    v_dot2_f32_bf16 v36, v98, v14, v36
    v_dot2_f32_bf16 v36, v99, v15, v36
    buffer_load_dwordx4 v[80:83], v2, s[8:11], s57 offen offset:2048 nt
    v_dot2_f32_bf16 v37, v100, v12, 0
    v_dot2_f32_bf16 v37, v101, v13, v37
    v_dot2_f32_bf16 v37, v102, v14, v37
    v_dot2_f32_bf16 v37, v103, v15, v37
    v_dot2_f32_bf16 v38, v104, v12, 0
    v_dot2_f32_bf16 v38, v105, v13, v38
    v_dot2_f32_bf16 v38, v106, v14, v38
    v_dot2_f32_bf16 v38, v107, v15, v38
    v_dot2_f32_bf16 v39, v108, v12, 0
    v_dot2_f32_bf16 v39, v109, v13, v39
    v_dot2_f32_bf16 v39, v110, v14, v39
    v_dot2_f32_bf16 v39, v111, v15, v39
    v_dot2_f32_bf16 v40, v112, v12, 0
    v_dot2_f32_bf16 v40, v113, v13, v40
    v_dot2_f32_bf16 v40, v114, v14, v40
    v_dot2_f32_bf16 v40, v115, v15, v40
    v_dot2_f32_bf16 v41, v116, v12, 0
    v_dot2_f32_bf16 v41, v117, v13, v41
    v_dot2_f32_bf16 v41, v118, v14, v41
    v_dot2_f32_bf16 v41, v119, v15, v41
    v_add_f32_dpp v32, v32, v32 row_ror:8 row_mask:0xf bank_mask:0x3
    s_nop 1
    v_add_f32_dpp v32, v40, v40 row_ror:8 row_mask:0xf bank_mask:0xc
    v_dot2_f32_bf16 v42, v120, v12, 0
    v_dot2_f32_bf16 v42, v121, v13, v42
    v_dot2_f32_bf16 v42, v122, v14, v42
    v_dot2_f32_bf16 v42, v123, v15, v42
    v_add_f32_dpp v33, v33, v33 row_ror:8 row_mask:0xf bank_mask:0x3
    s_nop 1
    v_add_f32_dpp v33, v41, v41 row_ror:8 row_mask:0xf bank_mask:0xc
    v_dot2_f32_bf16 v43, v124, v12, 0
    v_dot2_f32_bf16 v43, v125, v13, v43
    v_dot2_f32_bf16 v43, v126, v14, v43
    v_dot2_f32_bf16 v43, v127, v15, v43
    v_add_f32_dpp v34, v34, v34 row_ror:8 row_mask:0xf bank_mask:0x3
    s_nop 1
    v_add_f32_dpp v34, v42, v42 row_ror:8 row_mask:0xf bank_mask:0xc
    buffer_load_dwordx4 v[84:87], v2, s[8:11], s57 offen offset:3072 nt
    v_dot2_f32_bf16 v0, v128, v12, 0
    v_dot2_f32_bf16 v0, v129, v13, v0
    v_dot2_f32_bf16 v0, v130, v14, v0
    v_dot2_f32_bf16 v0, v131, v15, v0
    v_add_f32_dpp v35, v35, v35 row_ror:8 row_mask:0xf bank_mask:0x3
    s_nop 1
    v_add_f32_dpp v35, v43, v43 row_ror:8 row_mask:0xf bank_mask:0xc
    v_dot2_f32_bf16 v3, v132, v12, 0
    v_dot2_f32_bf16 v3, v133, v13, v3
    v_dot2_f32_bf16 v3, v134, v14, v3
    v_dot2_f32_bf16 v3, v135, v15, v3
    v_add_f32_dpp v36, v36, v36 row_ror:8 row_mask:0xf bank_mask:0x3
    s_nop 1
    v_add_f32_dpp v36, v0, v0 row_ror:8 row_mask:0xf bank_mask:0xc
    v_dot2_f32_bf16 v164, v136, v12, 0
    v_dot2_f32_bf16 v164, v137, v13, v164
    v_dot2_f32_bf16 v164, v138, v14, v164
    v_dot2_f32_bf16 v164, v139, v15, v164
    v_add_f32_dpp v37, v37, v37 row_ror:8 row_mask:0xf bank_mask:0x3
    s_nop 1
    v_add_f32_dpp v37, v3, v3 row_ror:8 row_mask:0xf bank_mask:0xc
    v_dot2_f32_bf16 v165, v140, v12, 0
    v_dot2_f32_bf16 v165, v141, v13, v165
    v_dot2_f32_bf16 v165, v142, v14, v165
    v_dot2_f32_bf16 v165, v143, v15, v165
    v_add_f32_dpp v38, v38, v38 row_ror:8 row_mask:0xf bank_mask:0x3
    s_nop 1
    v_add_f32_dpp v38, v164, v164 row_ror:8 row_mask:0xf bank_mask:0xc
    v_add_f32_dpp v32, v32, v32 row_shl:4 row_mask:0xf bank_mask:0x5
    s_nop 1
    v_add_f32_dpp v32, v36, v36 row_shr:4 row_mask:0xf bank_mask:0xa
    v_add_f32_dpp v33, v33, v33 row_shl:4 row_mask:0xf bank_mask:0x5
    s_nop 1
    v_add_f32_dpp v33, v37, v37 row_shr:4 row_mask:0xf bank_mask:0xa
    v_add_f32_dpp v34, v34, v34 row_shl:4 row_mask:0xf bank_mask:0x5
    s_nop 1
    v_add_f32_dpp v34, v38, v38 row_shr:4 row_mask:0xf bank_mask:0xa
    v_add_f32_dpp v39, v39, v39 row_ror:8 row_mask:0xf bank_mask:0x3
    s_nop 1
    v_add_f32_dpp v39, v165, v165 row_ror:8 row_mask:0xf bank_mask:0xc
    v_add_f32_dpp v40, v32, v32 quad_perm:[2,3,0,1] row_mask:0xf bank_mask:0xf
    v_add_f32_dpp v41, v34, v34 quad_perm:[2,3,0,1] row_mask:0xf bank_mask:0xf
    v_add_f32_dpp v35, v35, v35 row_shl:4 row_mask:0xf bank_mask:0x5
    s_nop 1
    v_add_f32_dpp v35, v39, v39 row_shr:4 row_mask:0xf bank_mask:0xa
    v_add_f32_dpp v42, v33, v33 quad_perm:[2,3,0,1] row_mask:0xf bank_mask:0xf
    v_cndmask_b32 v32, v40, v41, s[4:5]
    v_add_f32_dpp v43, v35, v35 quad_perm:[2,3,0,1] row_mask:0xf bank_mask:0xf
    s_nop 0
    v_add_f32_dpp v40, v32, v32 quad_perm:[1,0,3,2] row_mask:0xf bank_mask:0xf
    v_cndmask_b32 v33, v42, v43, s[4:5]
    s_nop 1
    v_add_f32_dpp v41, v33, v33 quad_perm:[1,0,3,2] row_mask:0xf bank_mask:0xf
    v_cndmask_b32 v16, v40, v41, s[6:7]
    v_cvt_pk_bf16_f32 v16, v16, v16
    v_and_b32 v16, 0xffff0000, v16
    v_mul_f32 v16, 0x3db504f3, v16
    v_cvt_pk_bf16_f32 v16, v16, v16
    v_and_b32 v16, 0xffff0000, v16
    ds_write_b16_d16_hi v4, v16 offset:38272
    v_mov_b32 v32, 1
    s_waitcnt lgkmcnt(0)
    s_mov_b64 exec, 1
    ds_add_u32 v163, v32 offset:37444
    s_mov_b64 exec, -1
    v_dot2_f32_bf16 v32, v144, v12, 0
    v_dot2_f32_bf16 v32, v145, v13, v32
    v_dot2_f32_bf16 v32, v146, v14, v32
    v_dot2_f32_bf16 v32, v147, v15, v32
    v_dot2_f32_bf16 v33, v148, v12, 0
    v_dot2_f32_bf16 v33, v149, v13, v33
    v_dot2_f32_bf16 v33, v150, v14, v33
    v_dot2_f32_bf16 v33, v151, v15, v33
    v_dot2_f32_bf16 v34, v76, v12, 0
    v_dot2_f32_bf16 v34, v77, v13, v34
    v_dot2_f32_bf16 v34, v78, v14, v34
    v_dot2_f32_bf16 v34, v79, v15, v34
    s_waitcnt vmcnt(4)
    v_dot2_f32_bf16 v35, v72, v12, 0
    v_dot2_f32_bf16 v35, v73, v13, v35
    v_dot2_f32_bf16 v35, v74, v14, v35
    v_dot2_f32_bf16 v35, v75, v15, v35
    s_waitcnt vmcnt(3)
    v_dot2_f32_bf16 v36, v68, v12, 0
    v_dot2_f32_bf16 v36, v69, v13, v36
    v_dot2_f32_bf16 v36, v70, v14, v36
    v_dot2_f32_bf16 v36, v71, v15, v36
    s_waitcnt vmcnt(2)
    s_add_u32 s57, s55, 262144
    buffer_load_dwordx4 v[88:91], v2, s[8:11], s57 offen offset:0 nt
    v_dot2_f32_bf16 v37, v64, v12, 0
    v_dot2_f32_bf16 v37, v65, v13, v37
    v_dot2_f32_bf16 v37, v66, v14, v37
    v_dot2_f32_bf16 v37, v67, v15, v37
    s_waitcnt vmcnt(2)
    buffer_load_dwordx4 v[92:95], v2, s[8:11], s57 offen offset:1024 nt
    v_dot2_f32_bf16 v38, v80, v12, 0
    v_dot2_f32_bf16 v38, v81, v13, v38
    v_dot2_f32_bf16 v38, v82, v14, v38
    v_dot2_f32_bf16 v38, v83, v15, v38
    s_waitcnt vmcnt(2)
    buffer_load_dwordx4 v[96:99], v2, s[8:11], s57 offen offset:2048 nt
    v_dot2_f32_bf16 v39, v84, v12, 0
    v_dot2_f32_bf16 v39, v85, v13, v39
    v_dot2_f32_bf16 v39, v86, v14, v39
    v_dot2_f32_bf16 v39, v87, v15, v39
    s_waitcnt vmcnt(2)
    buffer_load_dwordx4 v[100:103], v2, s[8:11], s57 offen offset:3072 nt
    v_dot2_f32_bf16 v40, v88, v12, 0
    v_dot2_f32_bf16 v40, v89, v13, v40
    v_dot2_f32_bf16 v40, v90, v14, v40
    v_dot2_f32_bf16 v40, v91, v15, v40
    s_waitcnt vmcnt(2)
    s_add_u32 s57, s55, 393216
    buffer_load_dwordx4 v[104:107], v2, s[8:11], s57 offen offset:0 nt
    v_dot2_f32_bf16 v41, v92, v12, 0
    v_dot2_f32_bf16 v41, v93, v13, v41
    v_dot2_f32_bf16 v41, v94, v14, v41
    v_dot2_f32_bf16 v41, v95, v15, v41
    v_add_f32_dpp v32, v32, v32 row_ror:8 row_mask:0xf bank_mask:0x3
    s_nop 1
    v_add_f32_dpp v32, v40, v40 row_ror:8 row_mask:0xf bank_mask:0xc
    s_waitcnt vmcnt(2)
    buffer_load_dwordx4 v[108:111], v2, s[8:11], s57 offen offset:1024 nt
    v_dot2_f32_bf16 v42, v96, v12, 0
    v_dot2_f32_bf16 v42, v97, v13, v42
    v_dot2_f32_bf16 v42, v98, v14, v42
    v_dot2_f32_bf16 v42, v99, v15, v42
    v_add_f32_dpp v33, v33, v33 row_ror:8 row_mask:0xf bank_mask:0x3
    s_nop 1
    v_add_f32_dpp v33, v41, v41 row_ror:8 row_mask:0xf bank_mask:0xc
    s_waitcnt vmcnt(2)
    buffer_load_dwordx4 v[112:115], v2, s[8:11], s57 offen offset:2048 nt
    v_dot2_f32_bf16 v43, v100, v12, 0
    v_dot2_f32_bf16 v43, v101, v13, v43
    v_dot2_f32_bf16 v43, v102, v14, v43
    v_dot2_f32_bf16 v43, v103, v15, v43
    v_add_f32_dpp v34, v34, v34 row_ror:8 row_mask:0xf bank_mask:0x3
    s_nop 1
    v_add_f32_dpp v34, v42, v42 row_ror:8 row_mask:0xf bank_mask:0xc
    s_waitcnt vmcnt(2)
    buffer_load_dwordx4 v[116:119], v2, s[8:11], s57 offen offset:3072 nt
    v_dot2_f32_bf16 v0, v104, v12, 0
    v_dot2_f32_bf16 v0, v105, v13, v0
    v_dot2_f32_bf16 v0, v106, v14, v0
    v_dot2_f32_bf16 v0, v107, v15, v0
    v_add_f32_dpp v35, v35, v35 row_ror:8 row_mask:0xf bank_mask:0x3
    s_nop 1
    v_add_f32_dpp v35, v43, v43 row_ror:8 row_mask:0xf bank_mask:0xc
    s_waitcnt vmcnt(2)
    s_add_u32 s57, s55, 524288
    buffer_load_dwordx4 v[120:123], v2, s[8:11], s57 offen offset:0 nt
    v_dot2_f32_bf16 v3, v108, v12, 0
    v_dot2_f32_bf16 v3, v109, v13, v3
    v_dot2_f32_bf16 v3, v110, v14, v3
    v_dot2_f32_bf16 v3, v111, v15, v3
    v_add_f32_dpp v36, v36, v36 row_ror:8 row_mask:0xf bank_mask:0x3
    s_nop 1
    v_add_f32_dpp v36, v0, v0 row_ror:8 row_mask:0xf bank_mask:0xc
    s_waitcnt vmcnt(2)
    buffer_load_dwordx4 v[124:127], v2, s[8:11], s57 offen offset:1024 nt
    v_dot2_f32_bf16 v164, v112, v12, 0
    v_dot2_f32_bf16 v164, v113, v13, v164
    v_dot2_f32_bf16 v164, v114, v14, v164
    v_dot2_f32_bf16 v164, v115, v15, v164
    v_add_f32_dpp v37, v37, v37 row_ror:8 row_mask:0xf bank_mask:0x3
    s_nop 1
    v_add_f32_dpp v37, v3, v3 row_ror:8 row_mask:0xf bank_mask:0xc
    s_waitcnt vmcnt(2)
    buffer_load_dwordx4 v[128:131], v2, s[8:11], s57 offen offset:2048 nt
    v_dot2_f32_bf16 v165, v116, v12, 0
    v_dot2_f32_bf16 v165, v117, v13, v165
    v_dot2_f32_bf16 v165, v118, v14, v165
    v_dot2_f32_bf16 v165, v119, v15, v165
    v_add_f32_dpp v38, v38, v38 row_ror:8 row_mask:0xf bank_mask:0x3
    s_nop 1
    v_add_f32_dpp v38, v164, v164 row_ror:8 row_mask:0xf bank_mask:0xc
    v_add_f32_dpp v32, v32, v32 row_shl:4 row_mask:0xf bank_mask:0x5
    s_nop 1
    v_add_f32_dpp v32, v36, v36 row_shr:4 row_mask:0xf bank_mask:0xa
    v_add_f32_dpp v33, v33, v33 row_shl:4 row_mask:0xf bank_mask:0x5
    s_nop 1
    v_add_f32_dpp v33, v37, v37 row_shr:4 row_mask:0xf bank_mask:0xa
    v_add_f32_dpp v34, v34, v34 row_shl:4 row_mask:0xf bank_mask:0x5
    s_nop 1
    v_add_f32_dpp v34, v38, v38 row_shr:4 row_mask:0xf bank_mask:0xa
    v_add_f32_dpp v39, v39, v39 row_ror:8 row_mask:0xf bank_mask:0x3
    s_nop 1
    v_add_f32_dpp v39, v165, v165 row_ror:8 row_mask:0xf bank_mask:0xc
    v_add_f32_dpp v40, v32, v32 quad_perm:[2,3,0,1] row_mask:0xf bank_mask:0xf
    v_add_f32_dpp v41, v34, v34 quad_perm:[2,3,0,1] row_mask:0xf bank_mask:0xf
    v_add_f32_dpp v35, v35, v35 row_shl:4 row_mask:0xf bank_mask:0x5
    s_nop 1
    v_add_f32_dpp v35, v39, v39 row_shr:4 row_mask:0xf bank_mask:0xa
    v_add_f32_dpp v42, v33, v33 quad_perm:[2,3,0,1] row_mask:0xf bank_mask:0xf
    v_cndmask_b32 v32, v40, v41, s[4:5]
    v_add_f32_dpp v43, v35, v35 quad_perm:[2,3,0,1] row_mask:0xf bank_mask:0xf
    s_nop 0
    v_add_f32_dpp v40, v32, v32 quad_perm:[1,0,3,2] row_mask:0xf bank_mask:0xf
    v_cndmask_b32 v33, v42, v43, s[4:5]
    s_nop 1
    v_add_f32_dpp v41, v33, v33 quad_perm:[1,0,3,2] row_mask:0xf bank_mask:0xf
    v_cndmask_b32 v17, v40, v41, s[6:7]
    v_cvt_pk_bf16_f32 v17, v17, v17
    v_and_b32 v17, 0xffff0000, v17
    v_mul_f32 v17, 0x3db504f3, v17
    v_cvt_pk_bf16_f32 v17, v17, v17
    v_and_b32 v17, 0xffff0000, v17
    s_waitcnt vmcnt(2)
    buffer_load_dwordx4 v[132:135], v2, s[8:11], s57 offen offset:3072 nt
    v_dot2_f32_bf16 v32, v120, v12, 0
    v_dot2_f32_bf16 v32, v121, v13, v32
    v_dot2_f32_bf16 v32, v122, v14, v32
    v_dot2_f32_bf16 v32, v123, v15, v32
    s_waitcnt vmcnt(2)
    s_add_u32 s57, s55, 655360
    buffer_load_dwordx4 v[136:139], v2, s[8:11], s57 offen offset:0 nt
    v_dot2_f32_bf16 v33, v124, v12, 0
    v_dot2_f32_bf16 v33, v125, v13, v33
    v_dot2_f32_bf16 v33, v126, v14, v33
    v_dot2_f32_bf16 v33, v127, v15, v33
    s_waitcnt vmcnt(2)
    buffer_load_dwordx4 v[140:143], v2, s[8:11], s57 offen offset:1024 nt
    v_dot2_f32_bf16 v34, v128, v12, 0
    v_dot2_f32_bf16 v34, v129, v13, v34
    v_dot2_f32_bf16 v34, v130, v14, v34
    v_dot2_f32_bf16 v34, v131, v15, v34
    s_waitcnt vmcnt(2)
    buffer_load_dwordx4 v[144:147], v2, s[8:11], s57 offen offset:2048 nt
    v_dot2_f32_bf16 v35, v132, v12, 0
    v_dot2_f32_bf16 v35, v133, v13, v35
    v_dot2_f32_bf16 v35, v134, v14, v35
    v_dot2_f32_bf16 v35, v135, v15, v35
    s_waitcnt vmcnt(2)
    buffer_load_dwordx4 v[148:151], v2, s[8:11], s57 offen offset:3072 nt
    v_dot2_f32_bf16 v36, v136, v12, 0
    v_dot2_f32_bf16 v36, v137, v13, v36
    v_dot2_f32_bf16 v36, v138, v14, v36
    v_dot2_f32_bf16 v36, v139, v15, v36
    s_waitcnt vmcnt(2)
    s_add_u32 s57, s55, 786432
    buffer_load_dwordx4 v[76:79], v2, s[8:11], s57 offen offset:0 nt
    v_dot2_f32_bf16 v37, v140, v12, 0
    v_dot2_f32_bf16 v37, v141, v13, v37
    v_dot2_f32_bf16 v37, v142, v14, v37
    v_dot2_f32_bf16 v37, v143, v15, v37
    s_waitcnt vmcnt(2)
    buffer_load_dwordx4 v[72:75], v2, s[8:11], s57 offen offset:1024 nt
    v_dot2_f32_bf16 v38, v144, v12, 0
    v_dot2_f32_bf16 v38, v145, v13, v38
    v_dot2_f32_bf16 v38, v146, v14, v38
    v_dot2_f32_bf16 v38, v147, v15, v38
    s_waitcnt vmcnt(2)
    buffer_load_dwordx4 v[68:71], v2, s[8:11], s57 offen offset:2048 nt
    v_dot2_f32_bf16 v39, v148, v12, 0
    v_dot2_f32_bf16 v39, v149, v13, v39
    v_dot2_f32_bf16 v39, v150, v14, v39
    v_dot2_f32_bf16 v39, v151, v15, v39
    s_waitcnt vmcnt(2)
    buffer_load_dwordx4 v[64:67], v2, s[8:11], s57 offen offset:3072 nt
    v_dot2_f32_bf16 v40, v76, v12, 0
    v_dot2_f32_bf16 v40, v77, v13, v40
    v_dot2_f32_bf16 v40, v78, v14, v40
    v_dot2_f32_bf16 v40, v79, v15, v40
    s_waitcnt vmcnt(2)
    s_add_u32 s57, s55, 917504
    buffer_load_dwordx4 v[80:83], v2, s[8:11], s57 offen offset:0 nt
    v_dot2_f32_bf16 v41, v72, v12, 0
    v_dot2_f32_bf16 v41, v73, v13, v41
    v_dot2_f32_bf16 v41, v74, v14, v41
    v_dot2_f32_bf16 v41, v75, v15, v41
    v_add_f32_dpp v32, v32, v32 row_ror:8 row_mask:0xf bank_mask:0x3
    s_nop 1
    v_add_f32_dpp v32, v40, v40 row_ror:8 row_mask:0xf bank_mask:0xc
    s_waitcnt vmcnt(2)
    buffer_load_dwordx4 v[84:87], v2, s[8:11], s57 offen offset:1024 nt
    v_dot2_f32_bf16 v42, v68, v12, 0
    v_dot2_f32_bf16 v42, v69, v13, v42
    v_dot2_f32_bf16 v42, v70, v14, v42
    v_dot2_f32_bf16 v42, v71, v15, v42
    v_add_f32_dpp v33, v33, v33 row_ror:8 row_mask:0xf bank_mask:0x3
    s_nop 1
    v_add_f32_dpp v33, v41, v41 row_ror:8 row_mask:0xf bank_mask:0xc
    s_waitcnt vmcnt(2)
    buffer_load_dwordx4 v[88:91], v2, s[8:11], s57 offen offset:2048 nt
    v_dot2_f32_bf16 v43, v64, v12, 0
    v_dot2_f32_bf16 v43, v65, v13, v43
    v_dot2_f32_bf16 v43, v66, v14, v43
    v_dot2_f32_bf16 v43, v67, v15, v43
    v_add_f32_dpp v34, v34, v34 row_ror:8 row_mask:0xf bank_mask:0x3
    s_nop 1
    v_add_f32_dpp v34, v42, v42 row_ror:8 row_mask:0xf bank_mask:0xc
    s_waitcnt vmcnt(2)
    buffer_load_dwordx4 v[92:95], v2, s[8:11], s57 offen offset:3072 nt
    v_dot2_f32_bf16 v0, v80, v12, 0
    v_dot2_f32_bf16 v0, v81, v13, v0
    v_dot2_f32_bf16 v0, v82, v14, v0
    v_dot2_f32_bf16 v0, v83, v15, v0
    v_add_f32_dpp v35, v35, v35 row_ror:8 row_mask:0xf bank_mask:0x3
    s_nop 1
    v_add_f32_dpp v35, v43, v43 row_ror:8 row_mask:0xf bank_mask:0xc
    s_waitcnt vmcnt(2)
    s_add_u32 s57, s55, 1048576
    buffer_load_dwordx4 v[96:99], v2, s[8:11], s57 offen offset:0 nt
    v_dot2_f32_bf16 v3, v84, v12, 0
    v_dot2_f32_bf16 v3, v85, v13, v3
    v_dot2_f32_bf16 v3, v86, v14, v3
    v_dot2_f32_bf16 v3, v87, v15, v3
    v_add_f32_dpp v36, v36, v36 row_ror:8 row_mask:0xf bank_mask:0x3
    s_nop 1
    v_add_f32_dpp v36, v0, v0 row_ror:8 row_mask:0xf bank_mask:0xc
    s_waitcnt vmcnt(2)
    buffer_load_dwordx4 v[100:103], v2, s[8:11], s57 offen offset:1024 nt
    v_dot2_f32_bf16 v164, v88, v12, 0
    v_dot2_f32_bf16 v164, v89, v13, v164
    v_dot2_f32_bf16 v164, v90, v14, v164
    v_dot2_f32_bf16 v164, v91, v15, v164
    v_add_f32_dpp v37, v37, v37 row_ror:8 row_mask:0xf bank_mask:0x3
    s_nop 1
    v_add_f32_dpp v37, v3, v3 row_ror:8 row_mask:0xf bank_mask:0xc
    s_waitcnt vmcnt(2)
    buffer_load_dwordx4 v[104:107], v2, s[8:11], s57 offen offset:2048 nt
    v_dot2_f32_bf16 v165, v92, v12, 0
    v_dot2_f32_bf16 v165, v93, v13, v165
    v_dot2_f32_bf16 v165, v94, v14, v165
    v_dot2_f32_bf16 v165, v95, v15, v165
    v_add_f32_dpp v38, v38, v38 row_ror:8 row_mask:0xf bank_mask:0x3
    s_nop 1
    v_add_f32_dpp v38, v164, v164 row_ror:8 row_mask:0xf bank_mask:0xc
    v_add_f32_dpp v32, v32, v32 row_shl:4 row_mask:0xf bank_mask:0x5
    s_nop 1
    v_add_f32_dpp v32, v36, v36 row_shr:4 row_mask:0xf bank_mask:0xa
    v_add_f32_dpp v33, v33, v33 row_shl:4 row_mask:0xf bank_mask:0x5
    s_nop 1
    v_add_f32_dpp v33, v37, v37 row_shr:4 row_mask:0xf bank_mask:0xa
    v_add_f32_dpp v34, v34, v34 row_shl:4 row_mask:0xf bank_mask:0x5
    s_nop 1
    v_add_f32_dpp v34, v38, v38 row_shr:4 row_mask:0xf bank_mask:0xa
    v_add_f32_dpp v39, v39, v39 row_ror:8 row_mask:0xf bank_mask:0x3
    s_nop 1
    v_add_f32_dpp v39, v165, v165 row_ror:8 row_mask:0xf bank_mask:0xc
    v_add_f32_dpp v40, v32, v32 quad_perm:[2,3,0,1] row_mask:0xf bank_mask:0xf
    v_add_f32_dpp v41, v34, v34 quad_perm:[2,3,0,1] row_mask:0xf bank_mask:0xf
    v_add_f32_dpp v35, v35, v35 row_shl:4 row_mask:0xf bank_mask:0x5
    s_nop 1
    v_add_f32_dpp v35, v39, v39 row_shr:4 row_mask:0xf bank_mask:0xa
    v_add_f32_dpp v42, v33, v33 quad_perm:[2,3,0,1] row_mask:0xf bank_mask:0xf
    v_cndmask_b32 v32, v40, v41, s[4:5]
    v_add_f32_dpp v43, v35, v35 quad_perm:[2,3,0,1] row_mask:0xf bank_mask:0xf
    s_nop 0
    v_add_f32_dpp v40, v32, v32 quad_perm:[1,0,3,2] row_mask:0xf bank_mask:0xf
    v_cndmask_b32 v33, v42, v43, s[4:5]
    s_nop 1
    v_add_f32_dpp v41, v33, v33 quad_perm:[1,0,3,2] row_mask:0xf bank_mask:0xf
    v_cndmask_b32 v18, v40, v41, s[6:7]
    v_cvt_pk_bf16_f32 v18, v18, v18
    v_and_b32 v18, 0xffff0000, v18
    v_mul_f32 v18, 0x3db504f3, v18
    v_cvt_pk_bf16_f32 v18, v18, v18
    v_and_b32 v18, 0xffff0000, v18
    s_waitcnt vmcnt(2)
    buffer_load_dwordx4 v[108:111], v2, s[8:11], s57 offen offset:3072 nt
    v_dot2_f32_bf16 v32, v96, v12, 0
    v_dot2_f32_bf16 v32, v97, v13, v32
    v_dot2_f32_bf16 v32, v98, v14, v32
    v_dot2_f32_bf16 v32, v99, v15, v32
    s_waitcnt vmcnt(2)
    s_add_u32 s57, s55, 1179648
    buffer_load_dwordx4 v[112:115], v2, s[8:11], s57 offen offset:0 nt
    v_dot2_f32_bf16 v33, v100, v12, 0
    v_dot2_f32_bf16 v33, v101, v13, v33
    v_dot2_f32_bf16 v33, v102, v14, v33
    v_dot2_f32_bf16 v33, v103, v15, v33
    s_waitcnt vmcnt(2)
    buffer_load_dwordx4 v[116:119], v2, s[8:11], s57 offen offset:1024 nt
    v_dot2_f32_bf16 v34, v104, v12, 0
    v_dot2_f32_bf16 v34, v105, v13, v34
    v_dot2_f32_bf16 v34, v106, v14, v34
    v_dot2_f32_bf16 v34, v107, v15, v34
    s_waitcnt vmcnt(2)
    buffer_load_dwordx4 v[120:123], v2, s[8:11], s57 offen offset:2048 nt
    v_dot2_f32_bf16 v35, v108, v12, 0
    v_dot2_f32_bf16 v35, v109, v13, v35
    v_dot2_f32_bf16 v35, v110, v14, v35
    v_dot2_f32_bf16 v35, v111, v15, v35
    s_waitcnt vmcnt(2)
    buffer_load_dwordx4 v[124:127], v2, s[8:11], s57 offen offset:3072 nt
    v_dot2_f32_bf16 v36, v112, v12, 0
    v_dot2_f32_bf16 v36, v113, v13, v36
    v_dot2_f32_bf16 v36, v114, v14, v36
    v_dot2_f32_bf16 v36, v115, v15, v36
    s_waitcnt vmcnt(2)
    s_add_u32 s57, s55, 1310720
    buffer_load_dwordx4 v[128:131], v2, s[8:11], s57 offen offset:0 nt
    v_dot2_f32_bf16 v37, v116, v12, 0
    v_dot2_f32_bf16 v37, v117, v13, v37
    v_dot2_f32_bf16 v37, v118, v14, v37
    v_dot2_f32_bf16 v37, v119, v15, v37
    s_waitcnt vmcnt(2)
    buffer_load_dwordx4 v[132:135], v2, s[8:11], s57 offen offset:1024 nt
    v_dot2_f32_bf16 v38, v120, v12, 0
    v_dot2_f32_bf16 v38, v121, v13, v38
    v_dot2_f32_bf16 v38, v122, v14, v38
    v_dot2_f32_bf16 v38, v123, v15, v38
    s_waitcnt vmcnt(2)
    buffer_load_dwordx4 v[136:139], v2, s[8:11], s57 offen offset:2048 nt
    v_dot2_f32_bf16 v39, v124, v12, 0
    v_dot2_f32_bf16 v39, v125, v13, v39
    v_dot2_f32_bf16 v39, v126, v14, v39
    v_dot2_f32_bf16 v39, v127, v15, v39
    s_waitcnt vmcnt(2)
    buffer_load_dwordx4 v[140:143], v2, s[8:11], s57 offen offset:3072 nt
    v_dot2_f32_bf16 v40, v128, v12, 0
    v_dot2_f32_bf16 v40, v129, v13, v40
    v_dot2_f32_bf16 v40, v130, v14, v40
    v_dot2_f32_bf16 v40, v131, v15, v40
    s_waitcnt vmcnt(2)
    s_add_u32 s57, s55, 1441792
    buffer_load_dwordx4 v[144:147], v2, s[8:11], s57 offen offset:0 nt
    v_dot2_f32_bf16 v41, v132, v12, 0
    v_dot2_f32_bf16 v41, v133, v13, v41
    v_dot2_f32_bf16 v41, v134, v14, v41
    v_dot2_f32_bf16 v41, v135, v15, v41
    v_add_f32_dpp v32, v32, v32 row_ror:8 row_mask:0xf bank_mask:0x3
    s_nop 1
    v_add_f32_dpp v32, v40, v40 row_ror:8 row_mask:0xf bank_mask:0xc
    s_waitcnt vmcnt(2)
    buffer_load_dwordx4 v[148:151], v2, s[8:11], s57 offen offset:1024 nt
    v_dot2_f32_bf16 v42, v136, v12, 0
    v_dot2_f32_bf16 v42, v137, v13, v42
    v_dot2_f32_bf16 v42, v138, v14, v42
    v_dot2_f32_bf16 v42, v139, v15, v42
    v_add_f32_dpp v33, v33, v33 row_ror:8 row_mask:0xf bank_mask:0x3
    s_nop 1
    v_add_f32_dpp v33, v41, v41 row_ror:8 row_mask:0xf bank_mask:0xc
    s_waitcnt vmcnt(2)
    buffer_load_dwordx4 v[80:83], v2, s[8:11], s57 offen offset:2048 nt
    v_dot2_f32_bf16 v43, v140, v12, 0
    v_dot2_f32_bf16 v43, v141, v13, v43
    v_dot2_f32_bf16 v43, v142, v14, v43
    v_dot2_f32_bf16 v43, v143, v15, v43
    v_add_f32_dpp v34, v34, v34 row_ror:8 row_mask:0xf bank_mask:0x3
    s_nop 1
    v_add_f32_dpp v34, v42, v42 row_ror:8 row_mask:0xf bank_mask:0xc
    s_waitcnt vmcnt(2)
    buffer_load_dwordx4 v[84:87], v2, s[8:11], s57 offen offset:3072 nt
    v_dot2_f32_bf16 v0, v144, v12, 0
    v_dot2_f32_bf16 v0, v145, v13, v0
    v_dot2_f32_bf16 v0, v146, v14, v0
    v_dot2_f32_bf16 v0, v147, v15, v0
    v_add_f32_dpp v35, v35, v35 row_ror:8 row_mask:0xf bank_mask:0x3
    s_nop 1
    v_add_f32_dpp v35, v43, v43 row_ror:8 row_mask:0xf bank_mask:0xc
    s_waitcnt vmcnt(2)
    buffer_load_dwordx4 v[48:51], v2, s[12:15], s55 offen offset:0 nt
    v_dot2_f32_bf16 v3, v148, v12, 0
    v_dot2_f32_bf16 v3, v149, v13, v3
    v_dot2_f32_bf16 v3, v150, v14, v3
    v_dot2_f32_bf16 v3, v151, v15, v3
    v_add_f32_dpp v36, v36, v36 row_ror:8 row_mask:0xf bank_mask:0x3
    s_nop 1
    v_add_f32_dpp v36, v0, v0 row_ror:8 row_mask:0xf bank_mask:0xc
    s_waitcnt vmcnt(2)
    buffer_load_dwordx4 v[52:55], v2, s[12:15], s55 offen offset:1024 nt
    v_dot2_f32_bf16 v164, v80, v12, 0
    v_dot2_f32_bf16 v164, v81, v13, v164
    v_dot2_f32_bf16 v164, v82, v14, v164
    v_dot2_f32_bf16 v164, v83, v15, v164
    v_add_f32_dpp v37, v37, v37 row_ror:8 row_mask:0xf bank_mask:0x3
    s_nop 1
    v_add_f32_dpp v37, v3, v3 row_ror:8 row_mask:0xf bank_mask:0xc
    s_waitcnt vmcnt(2)
    buffer_load_dwordx4 v[56:59], v2, s[12:15], s55 offen offset:2048 nt
    v_dot2_f32_bf16 v165, v84, v12, 0
    v_dot2_f32_bf16 v165, v85, v13, v165
    v_dot2_f32_bf16 v165, v86, v14, v165
    v_dot2_f32_bf16 v165, v87, v15, v165
    v_add_f32_dpp v38, v38, v38 row_ror:8 row_mask:0xf bank_mask:0x3
    s_nop 1
    v_add_f32_dpp v38, v164, v164 row_ror:8 row_mask:0xf bank_mask:0xc
    v_add_f32_dpp v32, v32, v32 row_shl:4 row_mask:0xf bank_mask:0x5
    s_nop 1
    v_add_f32_dpp v32, v36, v36 row_shr:4 row_mask:0xf bank_mask:0xa
    v_add_f32_dpp v33, v33, v33 row_shl:4 row_mask:0xf bank_mask:0x5
    s_nop 1
    v_add_f32_dpp v33, v37, v37 row_shr:4 row_mask:0xf bank_mask:0xa
    v_add_f32_dpp v34, v34, v34 row_shl:4 row_mask:0xf bank_mask:0x5
    s_nop 1
    v_add_f32_dpp v34, v38, v38 row_shr:4 row_mask:0xf bank_mask:0xa
    v_add_f32_dpp v39, v39, v39 row_ror:8 row_mask:0xf bank_mask:0x3
    s_nop 1
    v_add_f32_dpp v39, v165, v165 row_ror:8 row_mask:0xf bank_mask:0xc
    v_add_f32_dpp v40, v32, v32 quad_perm:[2,3,0,1] row_mask:0xf bank_mask:0xf
    v_add_f32_dpp v41, v34, v34 quad_perm:[2,3,0,1] row_mask:0xf bank_mask:0xf
    v_add_f32_dpp v35, v35, v35 row_shl:4 row_mask:0xf bank_mask:0x5
    s_nop 1
    v_add_f32_dpp v35, v39, v39 row_shr:4 row_mask:0xf bank_mask:0xa
    v_add_f32_dpp v42, v33, v33 quad_perm:[2,3,0,1] row_mask:0xf bank_mask:0xf
    v_cndmask_b32 v32, v40, v41, s[4:5]
    v_add_f32_dpp v43, v35, v35 quad_perm:[2,3,0,1] row_mask:0xf bank_mask:0xf
    s_nop 0
    v_add_f32_dpp v40, v32, v32 quad_perm:[1,0,3,2] row_mask:0xf bank_mask:0xf
    v_cndmask_b32 v33, v42, v43, s[4:5]
    s_nop 1
    v_add_f32_dpp v41, v33, v33 quad_perm:[1,0,3,2] row_mask:0xf bank_mask:0xf
    v_cndmask_b32 v19, v40, v41, s[6:7]
    v_cvt_pk_bf16_f32 v19, v19, v19
    v_and_b32 v19, 0xffff0000, v19
    v_mul_f32 v19, 0x3db504f3, v19
    v_cvt_pk_bf16_f32 v19, v19, v19
    v_and_b32 v19, 0xffff0000, v19
    v_max_f32 v32, v17, v18
    v_max_f32 v32, v32, v19
    s_nop 1
    v_max_f32_dpp v32, v32, v32 row_ror:8 row_mask:0xf bank_mask:0xf
    s_nop 1
    v_max_f32_dpp v32, v32, v32 row_ror:4 row_mask:0xf bank_mask:0xf
    s_nop 1
    v_max_f32_dpp v32, v32, v32 row_ror:2 row_mask:0xf bank_mask:0xf
    s_nop 1
    v_max_f32_dpp v32, v32, v32 row_ror:1 row_mask:0xf bank_mask:0xf
    s_nop 1
    v_max_f32_dpp v32, v32, v32 row_bcast:15 row_mask:0xa bank_mask:0xf
    s_nop 1
    v_max_f32_dpp v32, v32, v32 row_bcast:31 row_mask:0xc bank_mask:0xf
    s_nop 0
    v_readlane_b32 s59, v32, 63
    s_nop 1
    v_subrev_f32 v17, s59, v17
    v_mul_f32 v17, 0x3fb8aa3b, v17
    v_exp_f32 v17, v17
    v_subrev_f32 v18, s59, v18
    v_mul_f32 v18, 0x3fb8aa3b, v18
    v_exp_f32 v18, v18
    v_subrev_f32 v19, s59, v19
    v_mul_f32 v19, 0x3fb8aa3b, v19
    v_exp_f32 v19, v19
    v_mov_b32 v44, v17
    v_add_f32 v44, v44, v18
    v_add_f32 v44, v44, v19
    v_mul_f32 v44, 4.0, v44
    v_cvt_pk_bf16_f32 v17, v17, v17
    v_cvt_pk_bf16_f32 v18, v18, v18
    v_cvt_pk_bf16_f32 v19, v19, v19
    v_mov_b32 v46, 0
    s_mov_b32 s26, s55
    v_and_b32_dpp v24, v17, v8 row_newbcast:0 row_mask:0xf bank_mask:0xf
    v_and_b32_dpp v25, v17, v9 row_newbcast:0 row_mask:0xf bank_mask:0xf
    v_and_b32_dpp v26, v17, v10 row_newbcast:0 row_mask:0xf bank_mask:0xf
    v_and_b32_dpp v27, v17, v11 row_newbcast:0 row_mask:0xf bank_mask:0xf
    s_waitcnt vmcnt(2)
    buffer_load_dwordx4 v[60:63], v2, s[12:15], s26 offen offset:3072 nt
    v_mfma_f32_16x16x32_bf16 v[20:23], v[24:27], v[48:51], 0
    v_and_b32_dpp v28, v17, v8 row_newbcast:1 row_mask:0xf bank_mask:0xf
    v_and_b32_dpp v29, v17, v9 row_newbcast:1 row_mask:0xf bank_mask:0xf
    v_and_b32_dpp v30, v17, v10 row_newbcast:1 row_mask:0xf bank_mask:0xf
    v_and_b32_dpp v31, v17, v11 row_newbcast:1 row_mask:0xf bank_mask:0xf
    s_waitcnt vmcnt(2)
    s_add_u32 s27, s55, 131072
    buffer_load_dwordx4 v[64:67], v2, s[12:15], s27 offen offset:0 nt
    v_mfma_f32_16x16x32_bf16 v[20:23], v[28:31], v[52:55], v[20:23]
    v_and_b32_dpp v24, v17, v8 row_newbcast:2 row_mask:0xf bank_mask:0xf
    v_and_b32_dpp v25, v17, v9 row_newbcast:2 row_mask:0xf bank_mask:0xf
    v_and_b32_dpp v26, v17, v10 row_newbcast:2 row_mask:0xf bank_mask:0xf
    v_and_b32_dpp v27, v17, v11 row_newbcast:2 row_mask:0xf bank_mask:0xf
    s_waitcnt vmcnt(2)
    buffer_load_dwordx4 v[68:71], v2, s[12:15], s27 offen offset:1024 nt
    v_mfma_f32_16x16x32_bf16 v[20:23], v[24:27], v[56:59], v[20:23]
    v_and_b32_dpp v28, v17, v8 row_newbcast:3 row_mask:0xf bank_mask:0xf
    v_and_b32_dpp v29, v17, v9 row_newbcast:3 row_mask:0xf bank_mask:0xf
    v_and_b32_dpp v30, v17, v10 row_newbcast:3 row_mask:0xf bank_mask:0xf
    v_and_b32_dpp v31, v17, v11 row_newbcast:3 row_mask:0xf bank_mask:0xf
    s_waitcnt vmcnt(2)
    buffer_load_dwordx4 v[72:75], v2, s[12:15], s27 offen offset:2048 nt
    v_mfma_f32_16x16x32_bf16 v[20:23], v[28:31], v[60:63], v[20:23]
    s_mov_b32 s26, s27
    v_and_b32_dpp v24, v17, v8 row_newbcast:4 row_mask:0xf bank_mask:0xf
    v_and_b32_dpp v25, v17, v9 row_newbcast:4 row_mask:0xf bank_mask:0xf
    v_and_b32_dpp v26, v17, v10 row_newbcast:4 row_mask:0xf bank_mask:0xf
    v_and_b32_dpp v27, v17, v11 row_newbcast:4 row_mask:0xf bank_mask:0xf
    s_waitcnt vmcnt(2)
    buffer_load_dwordx4 v[76:79], v2, s[12:15], s26 offen offset:3072 nt
    v_mfma_f32_16x16x32_bf16 v[20:23], v[24:27], v[64:67], v[20:23]
    v_and_b32_dpp v28, v17, v8 row_newbcast:5 row_mask:0xf bank_mask:0xf
    v_and_b32_dpp v29, v17, v9 row_newbcast:5 row_mask:0xf bank_mask:0xf
    v_and_b32_dpp v30, v17, v10 row_newbcast:5 row_mask:0xf bank_mask:0xf
    v_and_b32_dpp v31, v17, v11 row_newbcast:5 row_mask:0xf bank_mask:0xf
    s_waitcnt vmcnt(2)
    s_add_u32 s27, s55, 262144
    buffer_load_dwordx4 v[48:51], v2, s[12:15], s27 offen offset:0 nt
    v_mfma_f32_16x16x32_bf16 v[20:23], v[28:31], v[68:71], v[20:23]
    v_and_b32_dpp v24, v17, v8 row_newbcast:6 row_mask:0xf bank_mask:0xf
    v_and_b32_dpp v25, v17, v9 row_newbcast:6 row_mask:0xf bank_mask:0xf
    v_and_b32_dpp v26, v17, v10 row_newbcast:6 row_mask:0xf bank_mask:0xf
    v_and_b32_dpp v27, v17, v11 row_newbcast:6 row_mask:0xf bank_mask:0xf
    s_waitcnt vmcnt(2)
    buffer_load_dwordx4 v[52:55], v2, s[12:15], s27 offen offset:1024 nt
    v_mfma_f32_16x16x32_bf16 v[20:23], v[24:27], v[72:75], v[20:23]
    v_and_b32_dpp v28, v17, v8 row_newbcast:7 row_mask:0xf bank_mask:0xf
    v_and_b32_dpp v29, v17, v9 row_newbcast:7 row_mask:0xf bank_mask:0xf
    v_and_b32_dpp v30, v17, v10 row_newbcast:7 row_mask:0xf bank_mask:0xf
    v_and_b32_dpp v31, v17, v11 row_newbcast:7 row_mask:0xf bank_mask:0xf
    s_waitcnt vmcnt(2)
    buffer_load_dwordx4 v[56:59], v2, s[12:15], s27 offen offset:2048 nt
    v_mfma_f32_16x16x32_bf16 v[20:23], v[28:31], v[76:79], v[20:23]
    s_mov_b32 s26, s27
    v_and_b32_dpp v24, v17, v8 row_newbcast:8 row_mask:0xf bank_mask:0xf
    v_and_b32_dpp v25, v17, v9 row_newbcast:8 row_mask:0xf bank_mask:0xf
    v_and_b32_dpp v26, v17, v10 row_newbcast:8 row_mask:0xf bank_mask:0xf
    v_and_b32_dpp v27, v17, v11 row_newbcast:8 row_mask:0xf bank_mask:0xf
    s_waitcnt vmcnt(2)
    buffer_load_dwordx4 v[60:63], v2, s[12:15], s26 offen offset:3072 nt
    v_mfma_f32_16x16x32_bf16 v[20:23], v[24:27], v[48:51], v[20:23]
    v_and_b32_dpp v28, v17, v8 row_newbcast:9 row_mask:0xf bank_mask:0xf
    v_and_b32_dpp v29, v17, v9 row_newbcast:9 row_mask:0xf bank_mask:0xf
    v_and_b32_dpp v30, v17, v10 row_newbcast:9 row_mask:0xf bank_mask:0xf
    v_and_b32_dpp v31, v17, v11 row_newbcast:9 row_mask:0xf bank_mask:0xf
    s_waitcnt vmcnt(2)
    s_add_u32 s27, s55, 393216
    buffer_load_dwordx4 v[64:67], v2, s[12:15], s27 offen offset:0 nt
    v_mfma_f32_16x16x32_bf16 v[20:23], v[28:31], v[52:55], v[20:23]
    v_and_b32_dpp v24, v17, v8 row_newbcast:10 row_mask:0xf bank_mask:0xf
    v_and_b32_dpp v25, v17, v9 row_newbcast:10 row_mask:0xf bank_mask:0xf
    v_and_b32_dpp v26, v17, v10 row_newbcast:10 row_mask:0xf bank_mask:0xf
    v_and_b32_dpp v27, v17, v11 row_newbcast:10 row_mask:0xf bank_mask:0xf
    s_waitcnt vmcnt(2)
    buffer_load_dwordx4 v[68:71], v2, s[12:15], s27 offen offset:1024 nt
    v_mfma_f32_16x16x32_bf16 v[20:23], v[24:27], v[56:59], v[20:23]
    v_and_b32_dpp v28, v17, v8 row_newbcast:11 row_mask:0xf bank_mask:0xf
    v_and_b32_dpp v29, v17, v9 row_newbcast:11 row_mask:0xf bank_mask:0xf
    v_and_b32_dpp v30, v17, v10 row_newbcast:11 row_mask:0xf bank_mask:0xf
    v_and_b32_dpp v31, v17, v11 row_newbcast:11 row_mask:0xf bank_mask:0xf
    s_waitcnt vmcnt(2)
    buffer_load_dwordx4 v[72:75], v2, s[12:15], s27 offen offset:2048 nt
    v_mfma_f32_16x16x32_bf16 v[20:23], v[28:31], v[60:63], v[20:23]
    s_mov_b32 s26, s27
    v_and_b32_dpp v24, v17, v8 row_newbcast:12 row_mask:0xf bank_mask:0xf
    v_and_b32_dpp v25, v17, v9 row_newbcast:12 row_mask:0xf bank_mask:0xf
    v_and_b32_dpp v26, v17, v10 row_newbcast:12 row_mask:0xf bank_mask:0xf
    v_and_b32_dpp v27, v17, v11 row_newbcast:12 row_mask:0xf bank_mask:0xf
    s_waitcnt vmcnt(2)
    buffer_load_dwordx4 v[76:79], v2, s[12:15], s26 offen offset:3072 nt
    v_mfma_f32_16x16x32_bf16 v[20:23], v[24:27], v[64:67], v[20:23]
    v_and_b32_dpp v28, v17, v8 row_newbcast:13 row_mask:0xf bank_mask:0xf
    v_and_b32_dpp v29, v17, v9 row_newbcast:13 row_mask:0xf bank_mask:0xf
    v_and_b32_dpp v30, v17, v10 row_newbcast:13 row_mask:0xf bank_mask:0xf
    v_and_b32_dpp v31, v17, v11 row_newbcast:13 row_mask:0xf bank_mask:0xf
    s_waitcnt vmcnt(2)
    s_add_u32 s27, s55, 524288
    buffer_load_dwordx4 v[48:51], v2, s[12:15], s27 offen offset:0 nt
    v_mfma_f32_16x16x32_bf16 v[20:23], v[28:31], v[68:71], v[20:23]
    v_and_b32_dpp v24, v17, v8 row_newbcast:14 row_mask:0xf bank_mask:0xf
    v_and_b32_dpp v25, v17, v9 row_newbcast:14 row_mask:0xf bank_mask:0xf
    v_and_b32_dpp v26, v17, v10 row_newbcast:14 row_mask:0xf bank_mask:0xf
    v_and_b32_dpp v27, v17, v11 row_newbcast:14 row_mask:0xf bank_mask:0xf
    s_waitcnt vmcnt(2)
    buffer_load_dwordx4 v[52:55], v2, s[12:15], s27 offen offset:1024 nt
    v_mfma_f32_16x16x32_bf16 v[20:23], v[24:27], v[72:75], v[20:23]
    v_and_b32_dpp v28, v17, v8 row_newbcast:15 row_mask:0xf bank_mask:0xf
    v_and_b32_dpp v29, v17, v9 row_newbcast:15 row_mask:0xf bank_mask:0xf
    v_and_b32_dpp v30, v17, v10 row_newbcast:15 row_mask:0xf bank_mask:0xf
    v_and_b32_dpp v31, v17, v11 row_newbcast:15 row_mask:0xf bank_mask:0xf
    s_waitcnt vmcnt(2)
    buffer_load_dwordx4 v[56:59], v2, s[12:15], s27 offen offset:2048 nt
    v_mfma_f32_16x16x32_bf16 v[20:23], v[28:31], v[76:79], v[20:23]
    s_mov_b32 s26, s27
    v_and_b32_dpp v24, v18, v8 row_newbcast:0 row_mask:0xf bank_mask:0xf
    v_and_b32_dpp v25, v18, v9 row_newbcast:0 row_mask:0xf bank_mask:0xf
    v_and_b32_dpp v26, v18, v10 row_newbcast:0 row_mask:0xf bank_mask:0xf
    v_and_b32_dpp v27, v18, v11 row_newbcast:0 row_mask:0xf bank_mask:0xf
    s_waitcnt vmcnt(2)
    buffer_load_dwordx4 v[60:63], v2, s[12:15], s26 offen offset:3072 nt
    v_mfma_f32_16x16x32_bf16 v[20:23], v[24:27], v[48:51], v[20:23]
    v_and_b32_dpp v28, v18, v8 row_newbcast:1 row_mask:0xf bank_mask:0xf
    v_and_b32_dpp v29, v18, v9 row_newbcast:1 row_mask:0xf bank_mask:0xf
    v_and_b32_dpp v30, v18, v10 row_newbcast:1 row_mask:0xf bank_mask:0xf
    v_and_b32_dpp v31, v18, v11 row_newbcast:1 row_mask:0xf bank_mask:0xf
    s_waitcnt vmcnt(2)
    s_add_u32 s27, s55, 655360
    buffer_load_dwordx4 v[64:67], v2, s[12:15], s27 offen offset:0 nt
    v_mfma_f32_16x16x32_bf16 v[20:23], v[28:31], v[52:55], v[20:23]
    v_and_b32_dpp v24, v18, v8 row_newbcast:2 row_mask:0xf bank_mask:0xf
    v_and_b32_dpp v25, v18, v9 row_newbcast:2 row_mask:0xf bank_mask:0xf
    v_and_b32_dpp v26, v18, v10 row_newbcast:2 row_mask:0xf bank_mask:0xf
    v_and_b32_dpp v27, v18, v11 row_newbcast:2 row_mask:0xf bank_mask:0xf
    s_waitcnt vmcnt(2)
    buffer_load_dwordx4 v[68:71], v2, s[12:15], s27 offen offset:1024 nt
    v_mfma_f32_16x16x32_bf16 v[20:23], v[24:27], v[56:59], v[20:23]
    v_and_b32_dpp v28, v18, v8 row_newbcast:3 row_mask:0xf bank_mask:0xf
    v_and_b32_dpp v29, v18, v9 row_newbcast:3 row_mask:0xf bank_mask:0xf
    v_and_b32_dpp v30, v18, v10 row_newbcast:3 row_mask:0xf bank_mask:0xf
    v_and_b32_dpp v31, v18, v11 row_newbcast:3 row_mask:0xf bank_mask:0xf
    s_waitcnt vmcnt(2)
    buffer_load_dwordx4 v[72:75], v2, s[12:15], s27 offen offset:2048 nt
    v_mfma_f32_16x16x32_bf16 v[20:23], v[28:31], v[60:63], v[20:23]
    s_mov_b32 s26, s27
    v_and_b32_dpp v24, v18, v8 row_newbcast:4 row_mask:0xf bank_mask:0xf
    v_and_b32_dpp v25, v18, v9 row_newbcast:4 row_mask:0xf bank_mask:0xf
    v_and_b32_dpp v26, v18, v10 row_newbcast:4 row_mask:0xf bank_mask:0xf
    v_and_b32_dpp v27, v18, v11 row_newbcast:4 row_mask:0xf bank_mask:0xf
    s_waitcnt vmcnt(2)
    buffer_load_dwordx4 v[76:79], v2, s[12:15], s26 offen offset:3072 nt
    v_mfma_f32_16x16x32_bf16 v[20:23], v[24:27], v[64:67], v[20:23]
    v_and_b32_dpp v28, v18, v8 row_newbcast:5 row_mask:0xf bank_mask:0xf
    v_and_b32_dpp v29, v18, v9 row_newbcast:5 row_mask:0xf bank_mask:0xf
    v_and_b32_dpp v30, v18, v10 row_newbcast:5 row_mask:0xf bank_mask:0xf
    v_and_b32_dpp v31, v18, v11 row_newbcast:5 row_mask:0xf bank_mask:0xf
    s_waitcnt vmcnt(2)
    s_add_u32 s27, s55, 786432
    buffer_load_dwordx4 v[48:51], v2, s[12:15], s27 offen offset:0 nt
    v_mfma_f32_16x16x32_bf16 v[20:23], v[28:31], v[68:71], v[20:23]
    v_and_b32_dpp v24, v18, v8 row_newbcast:6 row_mask:0xf bank_mask:0xf
    v_and_b32_dpp v25, v18, v9 row_newbcast:6 row_mask:0xf bank_mask:0xf
    v_and_b32_dpp v26, v18, v10 row_newbcast:6 row_mask:0xf bank_mask:0xf
    v_and_b32_dpp v27, v18, v11 row_newbcast:6 row_mask:0xf bank_mask:0xf
    s_waitcnt vmcnt(2)
    buffer_load_dwordx4 v[52:55], v2, s[12:15], s27 offen offset:1024 nt
    v_mfma_f32_16x16x32_bf16 v[20:23], v[24:27], v[72:75], v[20:23]
    v_and_b32_dpp v28, v18, v8 row_newbcast:7 row_mask:0xf bank_mask:0xf
    v_and_b32_dpp v29, v18, v9 row_newbcast:7 row_mask:0xf bank_mask:0xf
    v_and_b32_dpp v30, v18, v10 row_newbcast:7 row_mask:0xf bank_mask:0xf
    v_and_b32_dpp v31, v18, v11 row_newbcast:7 row_mask:0xf bank_mask:0xf
    s_waitcnt vmcnt(2)
    buffer_load_dwordx4 v[56:59], v2, s[12:15], s27 offen offset:2048 nt
    v_mfma_f32_16x16x32_bf16 v[20:23], v[28:31], v[76:79], v[20:23]
    s_mov_b32 s26, s27
    v_mov_b32 v33, 1
    ds_write_b32 v163, v33 offset:37440
    v_and_b32_dpp v24, v18, v8 row_newbcast:8 row_mask:0xf bank_mask:0xf
    v_and_b32_dpp v25, v18, v9 row_newbcast:8 row_mask:0xf bank_mask:0xf
    v_and_b32_dpp v26, v18, v10 row_newbcast:8 row_mask:0xf bank_mask:0xf
    v_and_b32_dpp v27, v18, v11 row_newbcast:8 row_mask:0xf bank_mask:0xf
    s_waitcnt vmcnt(2)
    buffer_load_dwordx4 v[60:63], v2, s[12:15], s26 offen offset:3072 nt
    v_mfma_f32_16x16x32_bf16 v[20:23], v[24:27], v[48:51], v[20:23]
    v_and_b32_dpp v28, v18, v8 row_newbcast:9 row_mask:0xf bank_mask:0xf
    v_and_b32_dpp v29, v18, v9 row_newbcast:9 row_mask:0xf bank_mask:0xf
    v_and_b32_dpp v30, v18, v10 row_newbcast:9 row_mask:0xf bank_mask:0xf
    v_and_b32_dpp v31, v18, v11 row_newbcast:9 row_mask:0xf bank_mask:0xf
    s_waitcnt vmcnt(2)
    s_add_u32 s27, s55, 917504
    buffer_load_dwordx4 v[64:67], v2, s[12:15], s27 offen offset:0 nt
    v_mfma_f32_16x16x32_bf16 v[20:23], v[28:31], v[52:55], v[20:23]
    v_and_b32_dpp v24, v18, v8 row_newbcast:10 row_mask:0xf bank_mask:0xf
    v_and_b32_dpp v25, v18, v9 row_newbcast:10 row_mask:0xf bank_mask:0xf
    v_and_b32_dpp v26, v18, v10 row_newbcast:10 row_mask:0xf bank_mask:0xf
    v_and_b32_dpp v27, v18, v11 row_newbcast:10 row_mask:0xf bank_mask:0xf
    s_waitcnt vmcnt(2)
    buffer_load_dwordx4 v[68:71], v2, s[12:15], s27 offen offset:1024 nt
    v_mfma_f32_16x16x32_bf16 v[20:23], v[24:27], v[56:59], v[20:23]
    v_and_b32_dpp v28, v18, v8 row_newbcast:11 row_mask:0xf bank_mask:0xf
    v_and_b32_dpp v29, v18, v9 row_newbcast:11 row_mask:0xf bank_mask:0xf
    v_and_b32_dpp v30, v18, v10 row_newbcast:11 row_mask:0xf bank_mask:0xf
    v_and_b32_dpp v31, v18, v11 row_newbcast:11 row_mask:0xf bank_mask:0xf
    s_waitcnt vmcnt(2)
    buffer_load_dwordx4 v[72:75], v2, s[12:15], s27 offen offset:2048 nt
    v_mfma_f32_16x16x32_bf16 v[20:23], v[28:31], v[60:63], v[20:23]
    s_mov_b32 s26, s27
    v_and_b32_dpp v24, v18, v8 row_newbcast:12 row_mask:0xf bank_mask:0xf
    v_and_b32_dpp v25, v18, v9 row_newbcast:12 row_mask:0xf bank_mask:0xf
    v_and_b32_dpp v26, v18, v10 row_newbcast:12 row_mask:0xf bank_mask:0xf
    v_and_b32_dpp v27, v18, v11 row_newbcast:12 row_mask:0xf bank_mask:0xf
    s_waitcnt vmcnt(2)
    buffer_load_dwordx4 v[76:79], v2, s[12:15], s26 offen offset:3072 nt
    v_mfma_f32_16x16x32_bf16 v[20:23], v[24:27], v[64:67], v[20:23]
    v_and_b32_dpp v28, v18, v8 row_newbcast:13 row_mask:0xf bank_mask:0xf
    v_and_b32_dpp v29, v18, v9 row_newbcast:13 row_mask:0xf bank_mask:0xf
    v_and_b32_dpp v30, v18, v10 row_newbcast:13 row_mask:0xf bank_mask:0xf
    v_and_b32_dpp v31, v18, v11 row_newbcast:13 row_mask:0xf bank_mask:0xf
    s_waitcnt vmcnt(2)
    s_add_u32 s27, s55, 1048576
    buffer_load_dwordx4 v[48:51], v2, s[12:15], s27 offen offset:0 nt
    v_mfma_f32_16x16x32_bf16 v[20:23], v[28:31], v[68:71], v[20:23]
    v_and_b32_dpp v24, v18, v8 row_newbcast:14 row_mask:0xf bank_mask:0xf
    v_and_b32_dpp v25, v18, v9 row_newbcast:14 row_mask:0xf bank_mask:0xf
    v_and_b32_dpp v26, v18, v10 row_newbcast:14 row_mask:0xf bank_mask:0xf
    v_and_b32_dpp v27, v18, v11 row_newbcast:14 row_mask:0xf bank_mask:0xf
    s_waitcnt vmcnt(2)
    buffer_load_dwordx4 v[52:55], v2, s[12:15], s27 offen offset:1024 nt
    v_mfma_f32_16x16x32_bf16 v[20:23], v[24:27], v[72:75], v[20:23]
    v_and_b32_dpp v28, v18, v8 row_newbcast:15 row_mask:0xf bank_mask:0xf
    v_and_b32_dpp v29, v18, v9 row_newbcast:15 row_mask:0xf bank_mask:0xf
    v_and_b32_dpp v30, v18, v10 row_newbcast:15 row_mask:0xf bank_mask:0xf
    v_and_b32_dpp v31, v18, v11 row_newbcast:15 row_mask:0xf bank_mask:0xf
    s_waitcnt vmcnt(2)
    buffer_load_dwordx4 v[56:59], v2, s[12:15], s27 offen offset:2048 nt
    v_mfma_f32_16x16x32_bf16 v[20:23], v[28:31], v[76:79], v[20:23]
    s_mov_b32 s26, s27
    v_and_b32_dpp v24, v19, v8 row_newbcast:0 row_mask:0xf bank_mask:0xf
    v_and_b32_dpp v25, v19, v9 row_newbcast:0 row_mask:0xf bank_mask:0xf
    v_and_b32_dpp v26, v19, v10 row_newbcast:0 row_mask:0xf bank_mask:0xf
    v_and_b32_dpp v27, v19, v11 row_newbcast:0 row_mask:0xf bank_mask:0xf
    s_waitcnt vmcnt(2)
    buffer_load_dwordx4 v[60:63], v2, s[12:15], s26 offen offset:3072 nt
    v_mfma_f32_16x16x32_bf16 v[20:23], v[24:27], v[48:51], v[20:23]
    v_and_b32_dpp v28, v19, v8 row_newbcast:1 row_mask:0xf bank_mask:0xf
    v_and_b32_dpp v29, v19, v9 row_newbcast:1 row_mask:0xf bank_mask:0xf
    v_and_b32_dpp v30, v19, v10 row_newbcast:1 row_mask:0xf bank_mask:0xf
    v_and_b32_dpp v31, v19, v11 row_newbcast:1 row_mask:0xf bank_mask:0xf
    s_waitcnt vmcnt(2)
    s_add_u32 s27, s55, 1179648
    buffer_load_dwordx4 v[64:67], v2, s[12:15], s27 offen offset:0 nt
    v_mfma_f32_16x16x32_bf16 v[20:23], v[28:31], v[52:55], v[20:23]
    v_and_b32_dpp v24, v19, v8 row_newbcast:2 row_mask:0xf bank_mask:0xf
    v_and_b32_dpp v25, v19, v9 row_newbcast:2 row_mask:0xf bank_mask:0xf
    v_and_b32_dpp v26, v19, v10 row_newbcast:2 row_mask:0xf bank_mask:0xf
    v_and_b32_dpp v27, v19, v11 row_newbcast:2 row_mask:0xf bank_mask:0xf
    s_waitcnt vmcnt(2)
    buffer_load_dwordx4 v[68:71], v2, s[12:15], s27 offen offset:1024 nt
    v_mfma_f32_16x16x32_bf16 v[20:23], v[24:27], v[56:59], v[20:23]
    v_and_b32_dpp v28, v19, v8 row_newbcast:3 row_mask:0xf bank_mask:0xf
    v_and_b32_dpp v29, v19, v9 row_newbcast:3 row_mask:0xf bank_mask:0xf
    v_and_b32_dpp v30, v19, v10 row_newbcast:3 row_mask:0xf bank_mask:0xf
    v_and_b32_dpp v31, v19, v11 row_newbcast:3 row_mask:0xf bank_mask:0xf
    s_waitcnt vmcnt(2)
    buffer_load_dwordx4 v[72:75], v2, s[12:15], s27 offen offset:2048 nt
    v_mfma_f32_16x16x32_bf16 v[20:23], v[28:31], v[60:63], v[20:23]
    s_mov_b32 s26, s27
    v_and_b32_dpp v24, v19, v8 row_newbcast:4 row_mask:0xf bank_mask:0xf
    v_and_b32_dpp v25, v19, v9 row_newbcast:4 row_mask:0xf bank_mask:0xf
    v_and_b32_dpp v26, v19, v10 row_newbcast:4 row_mask:0xf bank_mask:0xf
    v_and_b32_dpp v27, v19, v11 row_newbcast:4 row_mask:0xf bank_mask:0xf
    s_waitcnt vmcnt(2)
    buffer_load_dwordx4 v[76:79], v2, s[12:15], s26 offen offset:3072 nt
    v_mfma_f32_16x16x32_bf16 v[20:23], v[24:27], v[64:67], v[20:23]
    v_and_b32_dpp v28, v19, v8 row_newbcast:5 row_mask:0xf bank_mask:0xf
    v_and_b32_dpp v29, v19, v9 row_newbcast:5 row_mask:0xf bank_mask:0xf
    v_and_b32_dpp v30, v19, v10 row_newbcast:5 row_mask:0xf bank_mask:0xf
    v_and_b32_dpp v31, v19, v11 row_newbcast:5 row_mask:0xf bank_mask:0xf
    s_waitcnt vmcnt(2)
    s_add_u32 s27, s55, 1310720
    buffer_load_dwordx4 v[48:51], v2, s[12:15], s27 offen offset:0 nt
    v_mfma_f32_16x16x32_bf16 v[20:23], v[28:31], v[68:71], v[20:23]
    v_and_b32_dpp v24, v19, v8 row_newbcast:6 row_mask:0xf bank_mask:0xf
    v_and_b32_dpp v25, v19, v9 row_newbcast:6 row_mask:0xf bank_mask:0xf
    v_and_b32_dpp v26, v19, v10 row_newbcast:6 row_mask:0xf bank_mask:0xf
    v_and_b32_dpp v27, v19, v11 row_newbcast:6 row_mask:0xf bank_mask:0xf
    s_waitcnt vmcnt(2)
    buffer_load_dwordx4 v[52:55], v2, s[12:15], s27 offen offset:1024 nt
    v_mfma_f32_16x16x32_bf16 v[20:23], v[24:27], v[72:75], v[20:23]
    v_and_b32_dpp v28, v19, v8 row_newbcast:7 row_mask:0xf bank_mask:0xf
    v_and_b32_dpp v29, v19, v9 row_newbcast:7 row_mask:0xf bank_mask:0xf
    v_and_b32_dpp v30, v19, v10 row_newbcast:7 row_mask:0xf bank_mask:0xf
    v_and_b32_dpp v31, v19, v11 row_newbcast:7 row_mask:0xf bank_mask:0xf
    s_waitcnt vmcnt(2)
    buffer_load_dwordx4 v[56:59], v2, s[12:15], s27 offen offset:2048 nt
    v_mfma_f32_16x16x32_bf16 v[20:23], v[28:31], v[76:79], v[20:23]
    s_mov_b32 s26, s27
    v_and_b32_dpp v24, v19, v8 row_newbcast:8 row_mask:0xf bank_mask:0xf
    v_and_b32_dpp v25, v19, v9 row_newbcast:8 row_mask:0xf bank_mask:0xf
    v_and_b32_dpp v26, v19, v10 row_newbcast:8 row_mask:0xf bank_mask:0xf
    v_and_b32_dpp v27, v19, v11 row_newbcast:8 row_mask:0xf bank_mask:0xf
    s_waitcnt vmcnt(2)
    buffer_load_dwordx4 v[60:63], v2, s[12:15], s26 offen offset:3072 nt
    v_mfma_f32_16x16x32_bf16 v[20:23], v[24:27], v[48:51], v[20:23]
    v_and_b32_dpp v28, v19, v8 row_newbcast:9 row_mask:0xf bank_mask:0xf
    v_and_b32_dpp v29, v19, v9 row_newbcast:9 row_mask:0xf bank_mask:0xf
    v_and_b32_dpp v30, v19, v10 row_newbcast:9 row_mask:0xf bank_mask:0xf
    v_and_b32_dpp v31, v19, v11 row_newbcast:9 row_mask:0xf bank_mask:0xf
    s_waitcnt vmcnt(2)
    s_add_u32 s27, s55, 1441792
    v_mov_b32 v47, 1
    s_mov_b64 exec, 1
    buffer_atomic_add v47, off, s[28:31], s62 sc0 sc1
    s_mov_b64 exec, -1
    buffer_load_dwordx4 v[64:67], v2, s[12:15], s27 offen offset:0 nt
    v_mfma_f32_16x16x32_bf16 v[20:23], v[28:31], v[52:55], v[20:23]
    v_and_b32_dpp v24, v19, v8 row_newbcast:10 row_mask:0xf bank_mask:0xf
    v_and_b32_dpp v25, v19, v9 row_newbcast:10 row_mask:0xf bank_mask:0xf
    v_and_b32_dpp v26, v19, v10 row_newbcast:10 row_mask:0xf bank_mask:0xf
    v_and_b32_dpp v27, v19, v11 row_newbcast:10 row_mask:0xf bank_mask:0xf
    s_waitcnt vmcnt(3)
    buffer_load_dwordx4 v[68:71], v2, s[12:15], s27 offen offset:1024 nt
    v_mfma_f32_16x16x32_bf16 v[20:23], v[24:27], v[56:59], v[20:23]
    v_and_b32_dpp v28, v19, v8 row_newbcast:11 row_mask:0xf bank_mask:0xf
    v_and_b32_dpp v29, v19, v9 row_newbcast:11 row_mask:0xf bank_mask:0xf
    v_and_b32_dpp v30, v19, v10 row_newbcast:11 row_mask:0xf bank_mask:0xf
    v_and_b32_dpp v31, v19, v11 row_newbcast:11 row_mask:0xf bank_mask:0xf
    s_waitcnt vmcnt(3)
    buffer_load_dwordx4 v[72:75], v2, s[12:15], s27 offen offset:2048 nt
    v_mfma_f32_16x16x32_bf16 v[20:23], v[28:31], v[60:63], v[20:23]
    s_mov_b32 s26, s27
L_pk:
    ds_read_b32 v33, v163 offset:37448
    s_waitcnt lgkmcnt(0)
    v_readfirstlane_b32 s56, v33
    s_nop 0
    s_cmp_eq_u32 s56, 0
    s_cbranch_scc1 L_pk
    v_and_b32_dpp v24, v19, v8 row_newbcast:12 row_mask:0xf bank_mask:0xf
    v_and_b32_dpp v25, v19, v9 row_newbcast:12 row_mask:0xf bank_mask:0xf
    v_and_b32_dpp v26, v19, v10 row_newbcast:12 row_mask:0xf bank_mask:0xf
    v_and_b32_dpp v27, v19, v11 row_newbcast:12 row_mask:0xf bank_mask:0xf
    s_waitcnt vmcnt(2)
    buffer_load_dwordx4 v[76:79], v2, s[12:15], s26 offen offset:3072 nt
    v_mfma_f32_16x16x32_bf16 v[20:23], v[24:27], v[64:67], v[20:23]
    v_and_b32_dpp v28, v19, v8 row_newbcast:13 row_mask:0xf bank_mask:0xf
    v_and_b32_dpp v29, v19, v9 row_newbcast:13 row_mask:0xf bank_mask:0xf
    v_and_b32_dpp v30, v19, v10 row_newbcast:13 row_mask:0xf bank_mask:0xf
    v_and_b32_dpp v31, v19, v11 row_newbcast:13 row_mask:0xf bank_mask:0xf
    s_waitcnt vmcnt(2)
    v_readfirstlane_b32 s27, v47
    s_nop 0
    s_cmp_ge_u32 s27, 104
    s_cbranch_scc1 L_v11_t
    v_mov_b32 v33, s27
    s_lshr_b32 s58, s27, 5
    s_and_b32 s41, s27, 31
    s_lshl_b32 s56, s41, 7
    s_lshl_b32 s27, s58, 5
    s_add_u32 s56, s56, s27
    s_add_u32 s56, s56, s63
    s_add_u32 s58, s58, 12
    s_bfe_u32 s27, s41, 0x50000
    s_lshl_b32 s27, s27, 12
    s_bfe_u32 s41, s58, 0x40000
    s_lshl_b32 s41, s41, 17
    s_or_b32 s27, s27, s41
    ds_write_b32 v163, v33 offset:37452
    v_mov_b32 v47, 1
    s_mov_b64 exec, 1
    buffer_atomic_add v47, off, s[28:31], s62 sc0 sc1
    s_mov_b64 exec, -1
    buffer_load_short_d16_hi v46, v162, s[28:31], s56 offen sc1
    buffer_load_dwordx4 v[48:51], v2, s[12:15], s27 offen offset:0 nt
    v_mfma_f32_16x16x32_bf16 v[20:23], v[28:31], v[68:71], v[20:23]
    v_and_b32_dpp v24, v19, v8 row_newbcast:14 row_mask:0xf bank_mask:0xf
    v_and_b32_dpp v25, v19, v9 row_newbcast:14 row_mask:0xf bank_mask:0xf
    v_and_b32_dpp v26, v19, v10 row_newbcast:14 row_mask:0xf bank_mask:0xf
    v_and_b32_dpp v27, v19, v11 row_newbcast:14 row_mask:0xf bank_mask:0xf
    s_waitcnt vmcnt(4)
    buffer_load_dwordx4 v[52:55], v2, s[12:15], s27 offen offset:1024 nt
    v_mfma_f32_16x16x32_bf16 v[20:23], v[24:27], v[72:75], v[20:23]
    v_and_b32_dpp v28, v19, v8 row_newbcast:15 row_mask:0xf bank_mask:0xf
    v_and_b32_dpp v29, v19, v9 row_newbcast:15 row_mask:0xf bank_mask:0xf
    v_and_b32_dpp v30, v19, v10 row_newbcast:15 row_mask:0xf bank_mask:0xf
    v_and_b32_dpp v31, v19, v11 row_newbcast:15 row_mask:0xf bank_mask:0xf
    s_waitcnt vmcnt(4)
    buffer_load_dwordx4 v[56:59], v2, s[12:15], s27 offen offset:2048 nt
    v_mfma_f32_16x16x32_bf16 v[20:23], v[28:31], v[76:79], v[20:23]
    s_mov_b32 s26, s27
L_d:
    s_waitcnt vmcnt(2)
    buffer_load_dwordx4 v[60:63], v2, s[12:15], s26 offen offset:3072 nt
    v_cmp_lt_f32 vcc, s59, v46
    s_cbranch_vccz L_d0_keep
    v_mov_b32 v32, v46
    s_nop 1
    v_max_f32_dpp v32, v32, v32 row_ror:8 row_mask:0xf bank_mask:0xf
    s_nop 1
    v_max_f32_dpp v32, v32, v32 row_ror:4 row_mask:0xf bank_mask:0xf
    s_nop 1
    v_max_f32_dpp v32, v32, v32 row_ror:2 row_mask:0xf bank_mask:0xf
    s_nop 1
    v_max_f32_dpp v32, v32, v32 row_ror:1 row_mask:0xf bank_mask:0xf
    s_nop 1
    v_max_f32_dpp v32, v32, v32 row_bcast:15 row_mask:0xa bank_mask:0xf
    s_nop 1
    v_max_f32_dpp v32, v32, v32 row_bcast:31 row_mask:0xc bank_mask:0xf
    s_nop 0
    v_readlane_b32 s60, v32, 63
    v_mov_b32 v32, s59
    s_nop 0
    v_subrev_f32 v32, s60, v32
    v_mul_f32 v32, 0x3fb8aa3b, v32
    v_exp_f32 v32, v32
    s_mov_b32 s59, s60
    v_mul_f32 v44, v44, v32
    s_nop 4
    v_mul_f32 v20, v20, v32
    v_mul_f32 v21, v21, v32
    v_mul_f32 v22, v22, v32
    v_mul_f32 v23, v23, v32
L_d0_keep:
    v_subrev_f32 v32, s59, v46
    v_mul_f32 v32, 0x3fb8aa3b, v32
    v_exp_f32 v32, v32
    s_nop 0
    v_cvt_pk_bf16_f32 v45, v32, v32
    v_add_f32 v44, v44, v32
    s_nop 0
    v_and_b32_dpp v24, v45, v8 row_newbcast:0 row_mask:0xf bank_mask:0xf
    v_and_b32_dpp v25, v45, v9 row_newbcast:0 row_mask:0xf bank_mask:0xf
    v_and_b32_dpp v26, v45, v10 row_newbcast:0 row_mask:0xf bank_mask:0xf
    v_and_b32_dpp v27, v45, v11 row_newbcast:0 row_mask:0xf bank_mask:0xf
    s_nop 1
    v_mfma_f32_16x16x32_bf16 v[20:23], v[24:27], v[48:51], v[20:23]
    v_and_b32_dpp v28, v45, v8 row_newbcast:4 row_mask:0xf bank_mask:0xf
    v_and_b32_dpp v29, v45, v9 row_newbcast:4 row_mask:0xf bank_mask:0xf
    v_and_b32_dpp v30, v45, v10 row_newbcast:4 row_mask:0xf bank_mask:0xf
    v_and_b32_dpp v31, v45, v11 row_newbcast:4 row_mask:0xf bank_mask:0xf
    s_waitcnt vmcnt(2)
    v_readfirstlane_b32 s27, v47
    s_nop 0
    s_cmp_ge_u32 s27, 104
    s_cbranch_scc1 L_d0_t
    v_mov_b32 v33, s27
    s_lshr_b32 s58, s27, 5
    s_and_b32 s41, s27, 31
    s_lshl_b32 s56, s41, 7
    s_lshl_b32 s27, s58, 5
    s_add_u32 s56, s56, s27
    s_add_u32 s56, s56, s63
    s_add_u32 s58, s58, 12
    s_bfe_u32 s27, s41, 0x50000
    s_lshl_b32 s27, s27, 12
    s_bfe_u32 s41, s58, 0x40000
    s_lshl_b32 s41, s41, 17
    s_or_b32 s27, s27, s41
    ds_write_b32 v163, v33 offset:37452
    v_mov_b32 v47, 1
    s_mov_b64 exec, 1
    buffer_atomic_add v47, off, s[28:31], s62 sc0 sc1
    s_mov_b64 exec, -1
    buffer_load_short_d16_hi v46, v162, s[28:31], s56 offen sc1
    buffer_load_dwordx4 v[64:67], v2, s[12:15], s27 offen offset:0 nt
    v_mfma_f32_16x16x32_bf16 v[20:23], v[28:31], v[52:55], v[20:23]
    v_and_b32_dpp v24, v45, v8 row_newbcast:8 row_mask:0xf bank_mask:0xf
    v_and_b32_dpp v25, v45, v9 row_newbcast:8 row_mask:0xf bank_mask:0xf
    v_and_b32_dpp v26, v45, v10 row_newbcast:8 row_mask:0xf bank_mask:0xf
    v_and_b32_dpp v27, v45, v11 row_newbcast:8 row_mask:0xf bank_mask:0xf
    s_waitcnt vmcnt(4)
    buffer_load_dwordx4 v[68:71], v2, s[12:15], s27 offen offset:1024 nt
    v_mfma_f32_16x16x32_bf16 v[20:23], v[24:27], v[56:59], v[20:23]
    v_and_b32_dpp v28, v45, v8 row_newbcast:12 row_mask:0xf bank_mask:0xf
    v_and_b32_dpp v29, v45, v9 row_newbcast:12 row_mask:0xf bank_mask:0xf
    v_and_b32_dpp v30, v45, v10 row_newbcast:12 row_mask:0xf bank_mask:0xf
    v_and_b32_dpp v31, v45, v11 row_newbcast:12 row_mask:0xf bank_mask:0xf
    s_waitcnt vmcnt(4)
    buffer_load_dwordx4 v[72:75], v2, s[12:15], s27 offen offset:2048 nt
    v_mfma_f32_16x16x32_bf16 v[20:23], v[28:31], v[60:63], v[20:23]
    s_mov_b32 s26, s27
    s_waitcnt vmcnt(2)
    buffer_load_dwordx4 v[76:79], v2, s[12:15], s26 offen offset:3072 nt
    v_cmp_lt_f32 vcc, s59, v46
    s_cbranch_vccz L_d1_keep
    v_mov_b32 v32, v46
    s_nop 1
    v_max_f32_dpp v32, v32, v32 row_ror:8 row_mask:0xf bank_mask:0xf
    s_nop 1
    v_max_f32_dpp v32, v32, v32 row_ror:4 row_mask:0xf bank_mask:0xf
    s_nop 1
    v_max_f32_dpp v32, v32, v32 row_ror:2 row_mask:0xf bank_mask:0xf
    s_nop 1
    v_max_f32_dpp v32, v32, v32 row_ror:1 row_mask:0xf bank_mask:0xf
    s_nop 1
    v_max_f32_dpp v32, v32, v32 row_bcast:15 row_mask:0xa bank_mask:0xf
    s_nop 1
    v_max_f32_dpp v32, v32, v32 row_bcast:31 row_mask:0xc bank_mask:0xf
    s_nop 0
    v_readlane_b32 s60, v32, 63
    v_mov_b32 v32, s59
    s_nop 0
    v_subrev_f32 v32, s60, v32
    v_mul_f32 v32, 0x3fb8aa3b, v32
    v_exp_f32 v32, v32
    s_mov_b32 s59, s60
    v_mul_f32 v44, v44, v32
    s_nop 4
    v_mul_f32 v20, v20, v32
    v_mul_f32 v21, v21, v32
    v_mul_f32 v22, v22, v32
    v_mul_f32 v23, v23, v32
L_d1_keep:
    v_subrev_f32 v32, s59, v46
    v_mul_f32 v32, 0x3fb8aa3b, v32
    v_exp_f32 v32, v32
    s_nop 0
    v_cvt_pk_bf16_f32 v45, v32, v32
    v_add_f32 v44, v44, v32
    s_nop 0
    v_and_b32_dpp v24, v45, v8 row_newbcast:0 row_mask:0xf bank_mask:0xf
    v_and_b32_dpp v25, v45, v9 row_newbcast:0 row_mask:0xf bank_mask:0xf
    v_and_b32_dpp v26, v45, v10 row_newbcast:0 row_mask:0xf bank_mask:0xf
    v_and_b32_dpp v27, v45, v11 row_newbcast:0 row_mask:0xf bank_mask:0xf
    s_nop 1
    v_mfma_f32_16x16x32_bf16 v[20:23], v[24:27], v[64:67], v[20:23]
    v_and_b32_dpp v28, v45, v8 row_newbcast:4 row_mask:0xf bank_mask:0xf
    v_and_b32_dpp v29, v45, v9 row_newbcast:4 row_mask:0xf bank_mask:0xf
    v_and_b32_dpp v30, v45, v10 row_newbcast:4 row_mask:0xf bank_mask:0xf
    v_and_b32_dpp v31, v45, v11 row_newbcast:4 row_mask:0xf bank_mask:0xf
    s_waitcnt vmcnt(2)
    v_readfirstlane_b32 s27, v47
    s_nop 0
    s_cmp_ge_u32 s27, 104
    s_cbranch_scc1 L_d1_t
    v_mov_b32 v33, s27
    s_lshr_b32 s58, s27, 5
    s_and_b32 s41, s27, 31
    s_lshl_b32 s56, s41, 7
    s_lshl_b32 s27, s58, 5
    s_add_u32 s56, s56, s27
    s_add_u32 s56, s56, s63
    s_add_u32 s58, s58, 12
    s_bfe_u32 s27, s41, 0x50000
    s_lshl_b32 s27, s27, 12
    s_bfe_u32 s41, s58, 0x40000
    s_lshl_b32 s41, s41, 17
    s_or_b32 s27, s27, s41
    ds_write_b32 v163, v33 offset:37452
    v_mov_b32 v47, 1
    s_mov_b64 exec, 1
    buffer_atomic_add v47, off, s[28:31], s62 sc0 sc1
    s_mov_b64 exec, -1
    buffer_load_short_d16_hi v46, v162, s[28:31], s56 offen sc1
    buffer_load_dwordx4 v[48:51], v2, s[12:15], s27 offen offset:0 nt
    v_mfma_f32_16x16x32_bf16 v[20:23], v[28:31], v[68:71], v[20:23]
    v_and_b32_dpp v24, v45, v8 row_newbcast:8 row_mask:0xf bank_mask:0xf
    v_and_b32_dpp v25, v45, v9 row_newbcast:8 row_mask:0xf bank_mask:0xf
    v_and_b32_dpp v26, v45, v10 row_newbcast:8 row_mask:0xf bank_mask:0xf
    v_and_b32_dpp v27, v45, v11 row_newbcast:8 row_mask:0xf bank_mask:0xf
    s_waitcnt vmcnt(4)
    buffer_load_dwordx4 v[52:55], v2, s[12:15], s27 offen offset:1024 nt
    v_mfma_f32_16x16x32_bf16 v[20:23], v[24:27], v[72:75], v[20:23]
    v_and_b32_dpp v28, v45, v8 row_newbcast:12 row_mask:0xf bank_mask:0xf
    v_and_b32_dpp v29, v45, v9 row_newbcast:12 row_mask:0xf bank_mask:0xf
    v_and_b32_dpp v30, v45, v10 row_newbcast:12 row_mask:0xf bank_mask:0xf
    v_and_b32_dpp v31, v45, v11 row_newbcast:12 row_mask:0xf bank_mask:0xf
    s_waitcnt vmcnt(4)
    buffer_load_dwordx4 v[56:59], v2, s[12:15], s27 offen offset:2048 nt
    v_mfma_f32_16x16x32_bf16 v[20:23], v[28:31], v[76:79], v[20:23]
    s_mov_b32 s26, s27
    s_branch L_d
L_v11_t:
    s_cmp_ge_u32 s27, 128
    s_cbranch_scc1 L_v11_x
    v_mov_b32 v33, s27
    s_lshr_b32 s58, s27, 5
    s_and_b32 s41, s27, 31
    s_lshl_b32 s56, s41, 7
    s_lshl_b32 s27, s58, 5
    s_add_u32 s56, s56, s27
    s_add_u32 s56, s56, s63
    s_add_u32 s58, s58, 12
    s_bfe_u32 s27, s41, 0x50000
    s_lshl_b32 s27, s27, 12
    s_bfe_u32 s41, s58, 0x40000
    s_lshl_b32 s41, s41, 17
    s_or_b32 s27, s27, s41
    ds_write_b32 v163, v33 offset:37452
    v_mov_b32 v47, 1
    s_mov_b64 exec, 1
    buffer_atomic_add v47, off, s[28:31], s62 sc0 sc1
    s_mov_b64 exec, -1
    buffer_load_short_d16_hi v46, v162, s[28:31], s56 offen sc1
    buffer_load_dwordx4 v[48:51], v2, s[12:15], s27 offen offset:0 nt
    buffer_load_dwordx4 v[52:55], v2, s[12:15], s27 offen offset:1024 nt
    buffer_load_dwordx4 v[56:59], v2, s[12:15], s27 offen offset:2048 nt
    buffer_load_dwordx4 v[60:63], v2, s[12:15], s27 offen offset:3072 nt
    v_mfma_f32_16x16x32_bf16 v[20:23], v[28:31], v[68:71], v[20:23]
    v_and_b32_dpp v24, v19, v8 row_newbcast:14 row_mask:0xf bank_mask:0xf
    v_and_b32_dpp v25, v19, v9 row_newbcast:14 row_mask:0xf bank_mask:0xf
    v_and_b32_dpp v26, v19, v10 row_newbcast:14 row_mask:0xf bank_mask:0xf
    v_and_b32_dpp v27, v19, v11 row_newbcast:14 row_mask:0xf bank_mask:0xf
    s_waitcnt vmcnt(7)
    s_nop 0
    v_mfma_f32_16x16x32_bf16 v[20:23], v[24:27], v[72:75], v[20:23]
    v_and_b32_dpp v28, v19, v8 row_newbcast:15 row_mask:0xf bank_mask:0xf
    v_and_b32_dpp v29, v19, v9 row_newbcast:15 row_mask:0xf bank_mask:0xf
    v_and_b32_dpp v30, v19, v10 row_newbcast:15 row_mask:0xf bank_mask:0xf
    v_and_b32_dpp v31, v19, v11 row_newbcast:15 row_mask:0xf bank_mask:0xf
    s_waitcnt vmcnt(6)
    s_nop 0
    v_mfma_f32_16x16x32_bf16 v[20:23], v[28:31], v[76:79], v[20:23]
    s_branch L_e0
L_d0_t:
    s_cmp_ge_u32 s27, 128
    s_cbranch_scc1 L_d0_x
    v_mov_b32 v33, s27
    s_lshr_b32 s58, s27, 5
    s_and_b32 s41, s27, 31
    s_lshl_b32 s56, s41, 7
    s_lshl_b32 s27, s58, 5
    s_add_u32 s56, s56, s27
    s_add_u32 s56, s56, s63
    s_add_u32 s58, s58, 12
    s_bfe_u32 s27, s41, 0x50000
    s_lshl_b32 s27, s27, 12
    s_bfe_u32 s41, s58, 0x40000
    s_lshl_b32 s41, s41, 17
    s_or_b32 s27, s27, s41
    ds_write_b32 v163, v33 offset:37452
    v_mov_b32 v47, 1
    s_mov_b64 exec, 1
    buffer_atomic_add v47, off, s[28:31], s62 sc0 sc1
    s_mov_b64 exec, -1
    buffer_load_short_d16_hi v46, v162, s[28:31], s56 offen sc1
    buffer_load_dwordx4 v[64:67], v2, s[12:15], s27 offen offset:0 nt
    buffer_load_dwordx4 v[68:71], v2, s[12:15], s27 offen offset:1024 nt
    buffer_load_dwordx4 v[72:75], v2, s[12:15], s27 offen offset:2048 nt
    buffer_load_dwordx4 v[76:79], v2, s[12:15], s27 offen offset:3072 nt
    v_mfma_f32_16x16x32_bf16 v[20:23], v[28:31], v[52:55], v[20:23]
    v_and_b32_dpp v24, v45, v8 row_newbcast:8 row_mask:0xf bank_mask:0xf
    v_and_b32_dpp v25, v45, v9 row_newbcast:8 row_mask:0xf bank_mask:0xf
    v_and_b32_dpp v26, v45, v10 row_newbcast:8 row_mask:0xf bank_mask:0xf
    v_and_b32_dpp v27, v45, v11 row_newbcast:8 row_mask:0xf bank_mask:0xf
    s_waitcnt vmcnt(7)
    s_nop 0
    v_mfma_f32_16x16x32_bf16 v[20:23], v[24:27], v[56:59], v[20:23]
    v_and_b32_dpp v28, v45, v8 row_newbcast:12 row_mask:0xf bank_mask:0xf
    v_and_b32_dpp v29, v45, v9 row_newbcast:12 row_mask:0xf bank_mask:0xf
    v_and_b32_dpp v30, v45, v10 row_newbcast:12 row_mask:0xf bank_mask:0xf
    v_and_b32_dpp v31, v45, v11 row_newbcast:12 row_mask:0xf bank_mask:0xf
    s_waitcnt vmcnt(6)
    s_nop 0
    v_mfma_f32_16x16x32_bf16 v[20:23], v[28:31], v[60:63], v[20:23]
    s_branch L_e4
L_d1_t:
    s_cmp_ge_u32 s27, 128
    s_cbranch_scc1 L_d1_x
    v_mov_b32 v33, s27
    s_lshr_b32 s58, s27, 5
    s_and_b32 s41, s27, 31
    s_lshl_b32 s56, s41, 7
    s_lshl_b32 s27, s58, 5
    s_add_u32 s56, s56, s27
    s_add_u32 s56, s56, s63
    s_add_u32 s58, s58, 12
    s_bfe_u32 s27, s41, 0x50000
    s_lshl_b32 s27, s27, 12
    s_bfe_u32 s41, s58, 0x40000
    s_lshl_b32 s41, s41, 17
    s_or_b32 s27, s27, s41
    ds_write_b32 v163, v33 offset:37452
    v_mov_b32 v47, 1
    s_mov_b64 exec, 1
    buffer_atomic_add v47, off, s[28:31], s62 sc0 sc1
    s_mov_b64 exec, -1
    buffer_load_short_d16_hi v46, v162, s[28:31], s56 offen sc1
    buffer_load_dwordx4 v[48:51], v2, s[12:15], s27 offen offset:0 nt
    buffer_load_dwordx4 v[52:55], v2, s[12:15], s27 offen offset:1024 nt
    buffer_load_dwordx4 v[56:59], v2, s[12:15], s27 offen offset:2048 nt
    buffer_load_dwordx4 v[60:63], v2, s[12:15], s27 offen offset:3072 nt
    v_mfma_f32_16x16x32_bf16 v[20:23], v[28:31], v[68:71], v[20:23]
    v_and_b32_dpp v24, v45, v8 row_newbcast:8 row_mask:0xf bank_mask:0xf
    v_and_b32_dpp v25, v45, v9 row_newbcast:8 row_mask:0xf bank_mask:0xf
    v_and_b32_dpp v26, v45, v10 row_newbcast:8 row_mask:0xf bank_mask:0xf
    v_and_b32_dpp v27, v45, v11 row_newbcast:8 row_mask:0xf bank_mask:0xf
    s_waitcnt vmcnt(7)
    s_nop 0
    v_mfma_f32_16x16x32_bf16 v[20:23], v[24:27], v[72:75], v[20:23]
    v_and_b32_dpp v28, v45, v8 row_newbcast:12 row_mask:0xf bank_mask:0xf
    v_and_b32_dpp v29, v45, v9 row_newbcast:12 row_mask:0xf bank_mask:0xf
    v_and_b32_dpp v30, v45, v10 row_newbcast:12 row_mask:0xf bank_mask:0xf
    v_and_b32_dpp v31, v45, v11 row_newbcast:12 row_mask:0xf bank_mask:0xf
    s_waitcnt vmcnt(6)
    s_nop 0
    v_mfma_f32_16x16x32_bf16 v[20:23], v[28:31], v[76:79], v[20:23]
    s_branch L_e0
L_e0:
    s_waitcnt vmcnt(3)
    v_cmp_lt_f32 vcc, s59, v46
    s_cbranch_vccz L_e0_keep
    v_mov_b32 v32, v46
    s_nop 1
    v_max_f32_dpp v32, v32, v32 row_ror:8 row_mask:0xf bank_mask:0xf
    s_nop 1
    v_max_f32_dpp v32, v32, v32 row_ror:4 row_mask:0xf bank_mask:0xf
    s_nop 1
    v_max_f32_dpp v32, v32, v32 row_ror:2 row_mask:0xf bank_mask:0xf
    s_nop 1
    v_max_f32_dpp v32, v32, v32 row_ror:1 row_mask:0xf bank_mask:0xf
    s_nop 1
    v_max_f32_dpp v32, v32, v32 row_bcast:15 row_mask:0xa bank_mask:0xf
    s_nop 1
    v_max_f32_dpp v32, v32, v32 row_bcast:31 row_mask:0xc bank_mask:0xf
    s_nop 0
    v_readlane_b32 s60, v32, 63
    v_mov_b32 v32, s59
    s_nop 0
    v_subrev_f32 v32, s60, v32
    v_mul_f32 v32, 0x3fb8aa3b, v32
    v_exp_f32 v32, v32
    s_mov_b32 s59, s60
    v_mul_f32 v44, v44, v32
    s_nop 4
    v_mul_f32 v20, v20, v32
    v_mul_f32 v21, v21, v32
    v_mul_f32 v22, v22, v32
    v_mul_f32 v23, v23, v32
L_e0_keep:
    v_subrev_f32 v32, s59, v46
    v_mul_f32 v32, 0x3fb8aa3b, v32
    v_exp_f32 v32, v32
    s_nop 0
    v_cvt_pk_bf16_f32 v45, v32, v32
    v_add_f32 v44, v44, v32
    v_readfirstlane_b32 s27, v47
    v_and_b32_dpp v24, v45, v8 row_newbcast:0 row_mask:0xf bank_mask:0xf
    v_and_b32_dpp v25, v45, v9 row_newbcast:0 row_mask:0xf bank_mask:0xf
    v_and_b32_dpp v26, v45, v10 row_newbcast:0 row_mask:0xf bank_mask:0xf
    v_and_b32_dpp v27, v45, v11 row_newbcast:0 row_mask:0xf bank_mask:0xf
    s_cmp_ge_u32 s27, 128
    s_cbranch_scc1 L_e0_x
    v_mov_b32 v33, s27
    s_lshr_b32 s58, s27, 5
    s_and_b32 s41, s27, 31
    s_lshl_b32 s56, s41, 7
    s_lshl_b32 s27, s58, 5
    s_add_u32 s56, s56, s27
    s_add_u32 s56, s56, s63
    s_add_u32 s58, s58, 12
    s_bfe_u32 s27, s41, 0x50000
    s_lshl_b32 s27, s27, 12
    s_bfe_u32 s41, s58, 0x40000
    s_lshl_b32 s41, s41, 17
    s_or_b32 s27, s27, s41
    ds_write_b32 v163, v33 offset:37452
    v_mov_b32 v47, 1
    s_mov_b64 exec, 1
    buffer_atomic_add v47, off, s[28:31], s62 sc0 sc1
    s_mov_b64 exec, -1
    buffer_load_short_d16_hi v46, v162, s[28:31], s56 offen sc1
    buffer_load_dwordx4 v[64:67], v2, s[12:15], s27 offen offset:0 nt
    buffer_load_dwordx4 v[68:71], v2, s[12:15], s27 offen offset:1024 nt
    buffer_load_dwordx4 v[72:75], v2, s[12:15], s27 offen offset:2048 nt
    buffer_load_dwordx4 v[76:79], v2, s[12:15], s27 offen offset:3072 nt
    v_mfma_f32_16x16x32_bf16 v[20:23], v[24:27], v[48:51], v[20:23]
    v_and_b32_dpp v28, v45, v8 row_newbcast:4 row_mask:0xf bank_mask:0xf
    v_and_b32_dpp v29, v45, v9 row_newbcast:4 row_mask:0xf bank_mask:0xf
    v_and_b32_dpp v30, v45, v10 row_newbcast:4 row_mask:0xf bank_mask:0xf
    v_and_b32_dpp v31, v45, v11 row_newbcast:4 row_mask:0xf bank_mask:0xf
    s_waitcnt vmcnt(8)
    s_nop 0
    v_mfma_f32_16x16x32_bf16 v[20:23], v[28:31], v[52:55], v[20:23]
    v_and_b32_dpp v24, v45, v8 row_newbcast:8 row_mask:0xf bank_mask:0xf
    v_and_b32_dpp v25, v45, v9 row_newbcast:8 row_mask:0xf bank_mask:0xf
    v_and_b32_dpp v26, v45, v10 row_newbcast:8 row_mask:0xf bank_mask:0xf
    v_and_b32_dpp v27, v45, v11 row_newbcast:8 row_mask:0xf bank_mask:0xf
    s_waitcnt vmcnt(7)
    s_nop 0
    v_mfma_f32_16x16x32_bf16 v[20:23], v[24:27], v[56:59], v[20:23]
    v_and_b32_dpp v28, v45, v8 row_newbcast:12 row_mask:0xf bank_mask:0xf
    v_and_b32_dpp v29, v45, v9 row_newbcast:12 row_mask:0xf bank_mask:0xf
    v_and_b32_dpp v30, v45, v10 row_newbcast:12 row_mask:0xf bank_mask:0xf
    v_and_b32_dpp v31, v45, v11 row_newbcast:12 row_mask:0xf bank_mask:0xf
    s_waitcnt vmcnt(6)
    s_nop 0
    v_mfma_f32_16x16x32_bf16 v[20:23], v[28:31], v[60:63], v[20:23]
L_e4:
    s_waitcnt vmcnt(3)
    v_cmp_lt_f32 vcc, s59, v46
    s_cbranch_vccz L_e4_keep
    v_mov_b32 v32, v46
    s_nop 1
    v_max_f32_dpp v32, v32, v32 row_ror:8 row_mask:0xf bank_mask:0xf
    s_nop 1
    v_max_f32_dpp v32, v32, v32 row_ror:4 row_mask:0xf bank_mask:0xf
    s_nop 1
    v_max_f32_dpp v32, v32, v32 row_ror:2 row_mask:0xf bank_mask:0xf
    s_nop 1
    v_max_f32_dpp v32, v32, v32 row_ror:1 row_mask:0xf bank_mask:0xf
    s_nop 1
    v_max_f32_dpp v32, v32, v32 row_bcast:15 row_mask:0xa bank_mask:0xf
    s_nop 1
    v_max_f32_dpp v32, v32, v32 row_bcast:31 row_mask:0xc bank_mask:0xf
    s_nop 0
    v_readlane_b32 s60, v32, 63
    v_mov_b32 v32, s59
    s_nop 0
    v_subrev_f32 v32, s60, v32
    v_mul_f32 v32, 0x3fb8aa3b, v32
    v_exp_f32 v32, v32
    s_mov_b32 s59, s60
    v_mul_f32 v44, v44, v32
    s_nop 4
    v_mul_f32 v20, v20, v32
    v_mul_f32 v21, v21, v32
    v_mul_f32 v22, v22, v32
    v_mul_f32 v23, v23, v32
L_e4_keep:
    v_subrev_f32 v32, s59, v46
    v_mul_f32 v32, 0x3fb8aa3b, v32
    v_exp_f32 v32, v32
    s_nop 0
    v_cvt_pk_bf16_f32 v45, v32, v32
    v_add_f32 v44, v44, v32
    v_readfirstlane_b32 s27, v47
    v_and_b32_dpp v24, v45, v8 row_newbcast:0 row_mask:0xf bank_mask:0xf
    v_and_b32_dpp v25, v45, v9 row_newbcast:0 row_mask:0xf bank_mask:0xf
    v_and_b32_dpp v26, v45, v10 row_newbcast:0 row_mask:0xf bank_mask:0xf
    v_and_b32_dpp v27, v45, v11 row_newbcast:0 row_mask:0xf bank_mask:0xf
    s_cmp_ge_u32 s27, 128
    s_cbranch_scc1 L_e4_x
    v_mov_b32 v33, s27
    s_lshr_b32 s58, s27, 5
    s_and_b32 s41, s27, 31
    s_lshl_b32 s56, s41, 7
    s_lshl_b32 s27, s58, 5
    s_add_u32 s56, s56, s27
    s_add_u32 s56, s56, s63
    s_add_u32 s58, s58, 12
    s_bfe_u32 s27, s41, 0x50000
    s_lshl_b32 s27, s27, 12
    s_bfe_u32 s41, s58, 0x40000
    s_lshl_b32 s41, s41, 17
    s_or_b32 s27, s27, s41
    ds_write_b32 v163, v33 offset:37452
    v_mov_b32 v47, 1
    s_mov_b64 exec, 1
    buffer_atomic_add v47, off, s[28:31], s62 sc0 sc1
    s_mov_b64 exec, -1
    buffer_load_short_d16_hi v46, v162, s[28:31], s56 offen sc1
    buffer_load_dwordx4 v[48:51], v2, s[12:15], s27 offen offset:0 nt
    buffer_load_dwordx4 v[52:55], v2, s[12:15], s27 offen offset:1024 nt
    buffer_load_dwordx4 v[56:59], v2, s[12:15], s27 offen offset:2048 nt
    buffer_load_dwordx4 v[60:63], v2, s[12:15], s27 offen offset:3072 nt
    v_mfma_f32_16x16x32_bf16 v[20:23], v[24:27], v[64:67], v[20:23]
    v_and_b32_dpp v28, v45, v8 row_newbcast:4 row_mask:0xf bank_mask:0xf
    v_and_b32_dpp v29, v45, v9 row_newbcast:4 row_mask:0xf bank_mask:0xf
    v_and_b32_dpp v30, v45, v10 row_newbcast:4 row_mask:0xf bank_mask:0xf
    v_and_b32_dpp v31, v45, v11 row_newbcast:4 row_mask:0xf bank_mask:0xf
    s_waitcnt vmcnt(8)
    s_nop 0
    v_mfma_f32_16x16x32_bf16 v[20:23], v[28:31], v[68:71], v[20:23]
    v_and_b32_dpp v24, v45, v8 row_newbcast:8 row_mask:0xf bank_mask:0xf
    v_and_b32_dpp v25, v45, v9 row_newbcast:8 row_mask:0xf bank_mask:0xf
    v_and_b32_dpp v26, v45, v10 row_newbcast:8 row_mask:0xf bank_mask:0xf
    v_and_b32_dpp v27, v45, v11 row_newbcast:8 row_mask:0xf bank_mask:0xf
    s_waitcnt vmcnt(7)
    s_nop 0
    v_mfma_f32_16x16x32_bf16 v[20:23], v[24:27], v[72:75], v[20:23]
    v_and_b32_dpp v28, v45, v8 row_newbcast:12 row_mask:0xf bank_mask:0xf
    v_and_b32_dpp v29, v45, v9 row_newbcast:12 row_mask:0xf bank_mask:0xf
    v_and_b32_dpp v30, v45, v10 row_newbcast:12 row_mask:0xf bank_mask:0xf
    v_and_b32_dpp v31, v45, v11 row_newbcast:12 row_mask:0xf bank_mask:0xf
    s_waitcnt vmcnt(6)
    s_nop 0
    v_mfma_f32_16x16x32_bf16 v[20:23], v[28:31], v[76:79], v[20:23]
    s_branch L_e0
L_v11_x:
    s_nop 1
    v_mfma_f32_16x16x32_bf16 v[20:23], v[28:31], v[68:71], v[20:23]
    v_add_f32_dpp v44, v44, v44 row_ror:8 row_mask:0xf bank_mask:0xf
    s_nop 1
    v_add_f32_dpp v44, v44, v44 row_ror:4 row_mask:0xf bank_mask:0xf
    s_nop 1
    v_add_f32_dpp v44, v44, v44 row_ror:2 row_mask:0xf bank_mask:0xf
    s_nop 1
    v_add_f32_dpp v44, v44, v44 row_ror:1 row_mask:0xf bank_mask:0xf
    s_nop 1
    v_add_f32_dpp v44, v44, v44 row_bcast:15 row_mask:0xa bank_mask:0xf
    s_nop 1
    v_add_f32_dpp v44, v44, v44 row_bcast:31 row_mask:0xc bank_mask:0xf
    s_nop 0
    v_readlane_b32 s60, v44, 63
    v_mov_b32 v34, 0x3fb8aa3b
    v_mov_b32 v35, 0x3e800000
    v_mul_f32 v34, s59, v34
    v_mul_f32 v35, s60, v35
    ds_write_b64 v161, v[34:35] offset:36864
    v_mov_b32 v36, 128
    ds_write_b32 v163, v36 offset:37452
    v_and_b32_dpp v24, v19, v8 row_newbcast:14 row_mask:0xf bank_mask:0xf
    v_and_b32_dpp v25, v19, v9 row_newbcast:14 row_mask:0xf bank_mask:0xf
    v_and_b32_dpp v26, v19, v10 row_newbcast:14 row_mask:0xf bank_mask:0xf
    v_and_b32_dpp v27, v19, v11 row_newbcast:14 row_mask:0xf bank_mask:0xf
    s_waitcnt vmcnt(1)
    s_nop 0
    v_mfma_f32_16x16x32_bf16 v[20:23], v[24:27], v[72:75], v[20:23]
    v_and_b32_dpp v28, v19, v8 row_newbcast:15 row_mask:0xf bank_mask:0xf
    v_and_b32_dpp v29, v19, v9 row_newbcast:15 row_mask:0xf bank_mask:0xf
    v_and_b32_dpp v30, v19, v10 row_newbcast:15 row_mask:0xf bank_mask:0xf
    v_and_b32_dpp v31, v19, v11 row_newbcast:15 row_mask:0xf bank_mask:0xf
    s_waitcnt vmcnt(0)
    s_nop 0
    v_mfma_f32_16x16x32_bf16 v[20:23], v[28:31], v[76:79], v[20:23]
    s_branch L_fin
L_d0_x:
    s_nop 1
    v_mfma_f32_16x16x32_bf16 v[20:23], v[28:31], v[52:55], v[20:23]
    v_add_f32_dpp v44, v44, v44 row_ror:8 row_mask:0xf bank_mask:0xf
    s_nop 1
    v_add_f32_dpp v44, v44, v44 row_ror:4 row_mask:0xf bank_mask:0xf
    s_nop 1
    v_add_f32_dpp v44, v44, v44 row_ror:2 row_mask:0xf bank_mask:0xf
    s_nop 1
    v_add_f32_dpp v44, v44, v44 row_ror:1 row_mask:0xf bank_mask:0xf
    s_nop 1
    v_add_f32_dpp v44, v44, v44 row_bcast:15 row_mask:0xa bank_mask:0xf
    s_nop 1
    v_add_f32_dpp v44, v44, v44 row_bcast:31 row_mask:0xc bank_mask:0xf
    s_nop 0
    v_readlane_b32 s60, v44, 63
    v_mov_b32 v34, 0x3fb8aa3b
    v_mov_b32 v35, 0x3e800000
    v_mul_f32 v34, s59, v34
    v_mul_f32 v35, s60, v35
    ds_write_b64 v161, v[34:35] offset:36864
    v_mov_b32 v36, 128
    ds_write_b32 v163, v36 offset:37452
    v_and_b32_dpp v24, v45, v8 row_newbcast:8 row_mask:0xf bank_mask:0xf
    v_and_b32_dpp v25, v45, v9 row_newbcast:8 row_mask:0xf bank_mask:0xf
    v_and_b32_dpp v26, v45, v10 row_newbcast:8 row_mask:0xf bank_mask:0xf
    v_and_b32_dpp v27, v45, v11 row_newbcast:8 row_mask:0xf bank_mask:0xf
    s_waitcnt vmcnt(1)
    s_nop 0
    v_mfma_f32_16x16x32_bf16 v[20:23], v[24:27], v[56:59], v[20:23]
    v_and_b32_dpp v28, v45, v8 row_newbcast:12 row_mask:0xf bank_mask:0xf
    v_and_b32_dpp v29, v45, v9 row_newbcast:12 row_mask:0xf bank_mask:0xf
    v_and_b32_dpp v30, v45, v10 row_newbcast:12 row_mask:0xf bank_mask:0xf
    v_and_b32_dpp v31, v45, v11 row_newbcast:12 row_mask:0xf bank_mask:0xf
    s_waitcnt vmcnt(0)
    s_nop 0
    v_mfma_f32_16x16x32_bf16 v[20:23], v[28:31], v[60:63], v[20:23]
    s_branch L_fin
L_d1_x:
    s_nop 1
    v_mfma_f32_16x16x32_bf16 v[20:23], v[28:31], v[68:71], v[20:23]
    v_add_f32_dpp v44, v44, v44 row_ror:8 row_mask:0xf bank_mask:0xf
    s_nop 1
    v_add_f32_dpp v44, v44, v44 row_ror:4 row_mask:0xf bank_mask:0xf
    s_nop 1
    v_add_f32_dpp v44, v44, v44 row_ror:2 row_mask:0xf bank_mask:0xf
    s_nop 1
    v_add_f32_dpp v44, v44, v44 row_ror:1 row_mask:0xf bank_mask:0xf
    s_nop 1
    v_add_f32_dpp v44, v44, v44 row_bcast:15 row_mask:0xa bank_mask:0xf
    s_nop 1
    v_add_f32_dpp v44, v44, v44 row_bcast:31 row_mask:0xc bank_mask:0xf
    s_nop 0
    v_readlane_b32 s60, v44, 63
    v_mov_b32 v34, 0x3fb8aa3b
    v_mov_b32 v35, 0x3e800000
    v_mul_f32 v34, s59, v34
    v_mul_f32 v35, s60, v35
    ds_write_b64 v161, v[34:35] offset:36864
    v_mov_b32 v36, 128
    ds_write_b32 v163, v36 offset:37452
    v_and_b32_dpp v24, v45, v8 row_newbcast:8 row_mask:0xf bank_mask:0xf
    v_and_b32_dpp v25, v45, v9 row_newbcast:8 row_mask:0xf bank_mask:0xf
    v_and_b32_dpp v26, v45, v10 row_newbcast:8 row_mask:0xf bank_mask:0xf
    v_and_b32_dpp v27, v45, v11 row_newbcast:8 row_mask:0xf bank_mask:0xf
    s_waitcnt vmcnt(1)
    s_nop 0
    v_mfma_f32_16x16x32_bf16 v[20:23], v[24:27], v[72:75], v[20:23]
    v_and_b32_dpp v28, v45, v8 row_newbcast:12 row_mask:0xf bank_mask:0xf
    v_and_b32_dpp v29, v45, v9 row_newbcast:12 row_mask:0xf bank_mask:0xf
    v_and_b32_dpp v30, v45, v10 row_newbcast:12 row_mask:0xf bank_mask:0xf
    v_and_b32_dpp v31, v45, v11 row_newbcast:12 row_mask:0xf bank_mask:0xf
    s_waitcnt vmcnt(0)
    s_nop 0
    v_mfma_f32_16x16x32_bf16 v[20:23], v[28:31], v[76:79], v[20:23]
    s_branch L_fin
L_e0_x:
    s_nop 1
    v_mfma_f32_16x16x32_bf16 v[20:23], v[24:27], v[48:51], v[20:23]
    v_add_f32_dpp v44, v44, v44 row_ror:8 row_mask:0xf bank_mask:0xf
    s_nop 1
    v_add_f32_dpp v44, v44, v44 row_ror:4 row_mask:0xf bank_mask:0xf
    s_nop 1
    v_add_f32_dpp v44, v44, v44 row_ror:2 row_mask:0xf bank_mask:0xf
    s_nop 1
    v_add_f32_dpp v44, v44, v44 row_ror:1 row_mask:0xf bank_mask:0xf
    s_nop 1
    v_add_f32_dpp v44, v44, v44 row_bcast:15 row_mask:0xa bank_mask:0xf
    s_nop 1
    v_add_f32_dpp v44, v44, v44 row_bcast:31 row_mask:0xc bank_mask:0xf
    s_nop 0
    v_readlane_b32 s60, v44, 63
    v_mov_b32 v34, 0x3fb8aa3b
    v_mov_b32 v35, 0x3e800000
    v_mul_f32 v34, s59, v34
    v_mul_f32 v35, s60, v35
    ds_write_b64 v161, v[34:35] offset:36864
    v_mov_b32 v36, 128
    ds_write_b32 v163, v36 offset:37452
    v_and_b32_dpp v28, v45, v8 row_newbcast:4 row_mask:0xf bank_mask:0xf
    v_and_b32_dpp v29, v45, v9 row_newbcast:4 row_mask:0xf bank_mask:0xf
    v_and_b32_dpp v30, v45, v10 row_newbcast:4 row_mask:0xf bank_mask:0xf
    v_and_b32_dpp v31, v45, v11 row_newbcast:4 row_mask:0xf bank_mask:0xf
    s_waitcnt vmcnt(2)
    s_nop 0
    v_mfma_f32_16x16x32_bf16 v[20:23], v[28:31], v[52:55], v[20:23]
    v_and_b32_dpp v24, v45, v8 row_newbcast:8 row_mask:0xf bank_mask:0xf
    v_and_b32_dpp v25, v45, v9 row_newbcast:8 row_mask:0xf bank_mask:0xf
    v_and_b32_dpp v26, v45, v10 row_newbcast:8 row_mask:0xf bank_mask:0xf
    v_and_b32_dpp v27, v45, v11 row_newbcast:8 row_mask:0xf bank_mask:0xf
    s_waitcnt vmcnt(1)
    s_nop 0
    v_mfma_f32_16x16x32_bf16 v[20:23], v[24:27], v[56:59], v[20:23]
    v_and_b32_dpp v28, v45, v8 row_newbcast:12 row_mask:0xf bank_mask:0xf
    v_and_b32_dpp v29, v45, v9 row_newbcast:12 row_mask:0xf bank_mask:0xf
    v_and_b32_dpp v30, v45, v10 row_newbcast:12 row_mask:0xf bank_mask:0xf
    v_and_b32_dpp v31, v45, v11 row_newbcast:12 row_mask:0xf bank_mask:0xf
    s_waitcnt vmcnt(0)
    s_nop 0
    v_mfma_f32_16x16x32_bf16 v[20:23], v[28:31], v[60:63], v[20:23]
    s_branch L_fin
L_e4_x:
    s_nop 1
    v_mfma_f32_16x16x32_bf16 v[20:23], v[24:27], v[64:67], v[20:23]
    v_add_f32_dpp v44, v44, v44 row_ror:8 row_mask:0xf bank_mask:0xf
    s_nop 1
    v_add_f32_dpp v44, v44, v44 row_ror:4 row_mask:0xf bank_mask:0xf
    s_nop 1
    v_add_f32_dpp v44, v44, v44 row_ror:2 row_mask:0xf bank_mask:0xf
    s_nop 1
    v_add_f32_dpp v44, v44, v44 row_ror:1 row_mask:0xf bank_mask:0xf
    s_nop 1
    v_add_f32_dpp v44, v44, v44 row_bcast:15 row_mask:0xa bank_mask:0xf
    s_nop 1
    v_add_f32_dpp v44, v44, v44 row_bcast:31 row_mask:0xc bank_mask:0xf
    s_nop 0
    v_readlane_b32 s60, v44, 63
    v_mov_b32 v34, 0x3fb8aa3b
    v_mov_b32 v35, 0x3e800000
    v_mul_f32 v34, s59, v34
    v_mul_f32 v35, s60, v35
    ds_write_b64 v161, v[34:35] offset:36864
    v_mov_b32 v36, 128
    ds_write_b32 v163, v36 offset:37452
    v_and_b32_dpp v28, v45, v8 row_newbcast:4 row_mask:0xf bank_mask:0xf
    v_and_b32_dpp v29, v45, v9 row_newbcast:4 row_mask:0xf bank_mask:0xf
    v_and_b32_dpp v30, v45, v10 row_newbcast:4 row_mask:0xf bank_mask:0xf
    v_and_b32_dpp v31, v45, v11 row_newbcast:4 row_mask:0xf bank_mask:0xf
    s_waitcnt vmcnt(2)
    s_nop 0
    v_mfma_f32_16x16x32_bf16 v[20:23], v[28:31], v[68:71], v[20:23]
    v_and_b32_dpp v24, v45, v8 row_newbcast:8 row_mask:0xf bank_mask:0xf
    v_and_b32_dpp v25, v45, v9 row_newbcast:8 row_mask:0xf bank_mask:0xf
    v_and_b32_dpp v26, v45, v10 row_newbcast:8 row_mask:0xf bank_mask:0xf
    v_and_b32_dpp v27, v45, v11 row_newbcast:8 row_mask:0xf bank_mask:0xf
    s_waitcnt vmcnt(1)
    s_nop 0
    v_mfma_f32_16x16x32_bf16 v[20:23], v[24:27], v[72:75], v[20:23]
    v_and_b32_dpp v28, v45, v8 row_newbcast:12 row_mask:0xf bank_mask:0xf
    v_and_b32_dpp v29, v45, v9 row_newbcast:12 row_mask:0xf bank_mask:0xf
    v_and_b32_dpp v30, v45, v10 row_newbcast:12 row_mask:0xf bank_mask:0xf
    v_and_b32_dpp v31, v45, v11 row_newbcast:12 row_mask:0xf bank_mask:0xf
    s_waitcnt vmcnt(0)
    s_nop 0
    v_mfma_f32_16x16x32_bf16 v[20:23], v[28:31], v[76:79], v[20:23]
L_fin:
    s_mov_b32 exec_hi, 0
    s_nop 6
    ds_write_b128 v5, v[20:23] offset:32768
    s_mov_b64 exec, -1
    s_waitcnt lgkmcnt(0)
    s_barrier
    s_cmp_eq_u32 s3, 0
    s_cbranch_scc0 L_not0
    ds_read_b128 v[8:11], v153 offset:36864
    ds_read_b128 v[12:15], v153 offset:36880
    ds_read_b128 v[48:51], v152 offset:32768
    ds_read_b128 v[52:55], v152 offset:33280
    ds_read_b128 v[56:59], v152 offset:33792
    ds_read_b128 v[60:63], v152 offset:34304
    s_waitcnt lgkmcnt(4)
    v_max3_f32 v16, v8, v10, v12
    v_max_f32 v16, v16, v14
    v_sub_f32 v8, v8, v16
    v_sub_f32 v10, v10, v16
    v_sub_f32 v12, v12, v16
    v_sub_f32 v14, v14, v16
    v_exp_f32 v8, v8
    v_exp_f32 v10, v10
    v_exp_f32 v12, v12
    v_exp_f32 v14, v14
    s_waitcnt lgkmcnt(0)
    v_pk_mul_f32 v[20:21], v[48:49], v[8:9] op_sel_hi:[1,0]
    v_pk_mul_f32 v[22:23], v[50:51], v[8:9] op_sel_hi:[1,0]
    v_mul_f32 v17, v9, v8
    v_pk_fma_f32 v[20:21], v[52:53], v[10:11], v[20:21] op_sel_hi:[1,0,1]
    v_pk_fma_f32 v[22:23], v[54:55], v[10:11], v[22:23] op_sel_hi:[1,0,1]
    v_fmac_f32 v17, v11, v10
    v_pk_fma_f32 v[20:21], v[56:57], v[12:13], v[20:21] op_sel_hi:[1,0,1]
    v_pk_fma_f32 v[22:23], v[58:59], v[12:13], v[22:23] op_sel_hi:[1,0,1]
    v_fmac_f32 v17, v13, v12
    v_pk_fma_f32 v[20:21], v[60:61], v[14:15], v[20:21] op_sel_hi:[1,0,1]
    v_pk_fma_f32 v[22:23], v[62:63], v[14:15], v[22:23] op_sel_hi:[1,0,1]
    v_fmac_f32 v17, v15, v14
    buffer_store_dwordx4 v[20:23], v154, s[28:31], s40 offen sc1
    v_mov_b32 v18, v16
    v_mov_b32 v19, v17
    s_nop 0
    v_permlane32_swap_b32 v16, v18
    v_permlane32_swap_b32 v17, v19
    s_mov_b64 exec, 0xff
    buffer_store_dwordx4 v[16:19], v154, s[28:31], s40 offen offset:1024 sc1
    s_mov_b64 exec, -1
L_not0:
    s_cmp_eq_u32 s86, 1
    s_cbranch_scc0 L_end
    ds_read_b64_tr_b16 v[120:121], v155 offset:0
    ds_read_b64_tr_b16 v[122:123], v155 offset:1024
    ds_read_b64_tr_b16 v[124:125], v155 offset:8192
    ds_read_b64_tr_b16 v[126:127], v155 offset:9216
    ds_read_b64_tr_b16 v[128:129], v155 offset:16384
    ds_read_b64_tr_b16 v[130:131], v155 offset:17408
    ds_read_b64_tr_b16 v[132:133], v155 offset:24576
    ds_read_b64_tr_b16 v[134:135], v155 offset:25600
    s_cmp_eq_u32 s3, 1
    s_cbranch_scc0 L_b3
    v_add_u32 v44, 4608, v157
    s_waitcnt vmcnt(0)
    buffer_load_dwordx2 v[80:81], v156, s[28:31], s42 offen offset:1024 sc1
    buffer_load_dwordx4 v[48:51], v157, s[28:31], s42 offen offset:0 sc1
    buffer_load_dwordx4 v[52:55], v157, s[28:31], s42 offen offset:1152 sc1
    buffer_load_dwordx4 v[56:59], v157, s[28:31], s42 offen offset:2304 sc1
    buffer_load_dwordx4 v[60:63], v157, s[28:31], s42 offen offset:3456 sc1
    buffer_load_dwordx4 v[64:67], v44, s[28:31], s42 offen offset:0 sc1
    buffer_load_dwordx4 v[68:71], v44, s[28:31], s42 offen offset:1152 sc1
    buffer_load_dwordx4 v[72:75], v44, s[28:31], s42 offen offset:2304 sc1
    buffer_load_dwordx4 v[76:79], v44, s[28:31], s42 offen offset:3456 sc1
L_pw:
    s_waitcnt vmcnt(8)
    v_max_u32 v46, v80, v81
    v_max_f32_dpp v45, v80, v80 quad_perm:[1,0,3,2] row_mask:0xf bank_mask:0xf
    v_cmp_eq_u32 vcc, -1, v46
    s_cbranch_vccnz L_re0
    v_max_f32_dpp v45, v45, v45 quad_perm:[2,3,0,1] row_mask:0xf bank_mask:0xf
    s_nop 1
    v_max_f32_dpp v45, v45, v45 row_half_mirror row_mask:0xf bank_mask:0xf
    v_sub_f32 v45, v80, v45
    v_exp_f32 v45, v45
    s_nop 0
    v_mul_f32 v47, v45, v81
    s_nop 1
    v_add_f32_dpp v47, v47, v47 quad_perm:[1,0,3,2] row_mask:0xf bank_mask:0xf
    s_nop 1
    v_add_f32_dpp v47, v47, v47 quad_perm:[2,3,0,1] row_mask:0xf bank_mask:0xf
    s_nop 1
    v_add_f32_dpp v47, v47, v47 row_half_mirror row_mask:0xf bank_mask:0xf
    v_rcp_f32 v47, v47
    s_nop 0
    v_mul_f32 v45, v45, v47
    s_nop 1
    v_mov_b32_dpp v8, v45 row_newbcast:0 row_mask:0xf bank_mask:0x3
    v_mov_b32_dpp v10, v45 row_newbcast:1 row_mask:0xf bank_mask:0x3
    v_mov_b32_dpp v12, v45 row_newbcast:2 row_mask:0xf bank_mask:0x3
    v_mov_b32_dpp v14, v45 row_newbcast:3 row_mask:0xf bank_mask:0x3
    v_mov_b32_dpp v16, v45 row_newbcast:4 row_mask:0xf bank_mask:0x3
    v_mov_b32_dpp v18, v45 row_newbcast:5 row_mask:0xf bank_mask:0x3
    v_mov_b32_dpp v40, v45 row_newbcast:6 row_mask:0xf bank_mask:0x3
    v_mov_b32_dpp v42, v45 row_newbcast:7 row_mask:0xf bank_mask:0x3
    v_mov_b32_dpp v8, v45 row_newbcast:8 row_mask:0xf bank_mask:0xc
    v_mov_b32_dpp v10, v45 row_newbcast:9 row_mask:0xf bank_mask:0xc
    v_mov_b32_dpp v12, v45 row_newbcast:10 row_mask:0xf bank_mask:0xc
    v_mov_b32_dpp v14, v45 row_newbcast:11 row_mask:0xf bank_mask:0xc
    v_mov_b32_dpp v16, v45 row_newbcast:12 row_mask:0xf bank_mask:0xc
    v_mov_b32_dpp v18, v45 row_newbcast:13 row_mask:0xf bank_mask:0xc
    v_mov_b32_dpp v40, v45 row_newbcast:14 row_mask:0xf bank_mask:0xc
    v_mov_b32_dpp v42, v45 row_newbcast:15 row_mask:0xf bank_mask:0xc
    s_waitcnt vmcnt(0)
    v_max3_u32 v47, v48, v50, v52
    v_max3_u32 v46, v46, v54, v56
    v_max3_u32 v47, v47, v58, v60
    v_max3_u32 v46, v46, v62, v64
    v_max3_u32 v47, v47, v66, v68
    v_max3_u32 v46, v46, v70, v72
    v_max3_u32 v47, v47, v74, v76
    v_max3_u32 v46, v46, v47, v78
    v_cmp_eq_u32 vcc, -1, v46
    s_cbranch_vccz L_pok0
L_re0:
    buffer_load_dwordx2 v[80:81], v156, s[28:31], s42 offen offset:1024 sc1
    buffer_load_dwordx4 v[48:51], v157, s[28:31], s42 offen offset:0 sc1
    buffer_load_dwordx4 v[52:55], v157, s[28:31], s42 offen offset:1152 sc1
    buffer_load_dwordx4 v[56:59], v157, s[28:31], s42 offen offset:2304 sc1
    buffer_load_dwordx4 v[60:63], v157, s[28:31], s42 offen offset:3456 sc1
    buffer_load_dwordx4 v[64:67], v44, s[28:31], s42 offen offset:0 sc1
    buffer_load_dwordx4 v[68:71], v44, s[28:31], s42 offen offset:1152 sc1
    buffer_load_dwordx4 v[72:75], v44, s[28:31], s42 offen offset:2304 sc1
    buffer_load_dwordx4 v[76:79], v44, s[28:31], s42 offen offset:3456 sc1
    s_cmp_eq_u32 s61, 0
    s_cbranch_scc1 L_pok0
    s_sub_u32 s61, s61, 1
    s_branch L_pw
L_pok0:
    v_pk_mul_f32 v[20:21], v[48:49], v[8:9] op_sel_hi:[1,0]
    v_pk_mul_f32 v[22:23], v[50:51], v[8:9] op_sel_hi:[1,0]
    v_pk_mul_f32 v[24:25], v[52:53], v[10:11] op_sel_hi:[1,0]
    v_pk_mul_f32 v[26:27], v[54:55], v[10:11] op_sel_hi:[1,0]
    v_pk_fma_f32 v[20:21], v[56:57], v[12:13], v[20:21] op_sel_hi:[1,0,1]
    v_pk_fma_f32 v[22:23], v[58:59], v[12:13], v[22:23] op_sel_hi:[1,0,1]
    v_pk_fma_f32 v[24:25], v[60:61], v[14:15], v[24:25] op_sel_hi:[1,0,1]
    v_pk_fma_f32 v[26:27], v[62:63], v[14:15], v[26:27] op_sel_hi:[1,0,1]
    v_pk_fma_f32 v[20:21], v[64:65], v[16:17], v[20:21] op_sel_hi:[1,0,1]
    v_pk_fma_f32 v[22:23], v[66:67], v[16:17], v[22:23] op_sel_hi:[1,0,1]
    v_pk_fma_f32 v[24:25], v[68:69], v[18:19], v[24:25] op_sel_hi:[1,0,1]
    v_pk_fma_f32 v[26:27], v[70:71], v[18:19], v[26:27] op_sel_hi:[1,0,1]
    v_pk_fma_f32 v[20:21], v[72:73], v[40:41], v[20:21] op_sel_hi:[1,0,1]
    v_pk_fma_f32 v[22:23], v[74:75], v[40:41], v[22:23] op_sel_hi:[1,0,1]
    v_pk_fma_f32 v[24:25], v[76:77], v[42:43], v[24:25] op_sel_hi:[1,0,1]
    v_pk_fma_f32 v[26:27], v[78:79], v[42:43], v[26:27] op_sel_hi:[1,0,1]
L_pn:
    v_pk_add_f32 v[20:21], v[20:21], v[24:25]
    v_pk_add_f32 v[22:23], v[22:23], v[26:27]
    v_cvt_pk_bf16_f32 v20, v20, v21
    v_cvt_pk_bf16_f32 v21, v22, v23
    ds_write_b64 v158, v[20:21] offset:37760
L_b3:
    s_waitcnt lgkmcnt(0)
    s_barrier
    ds_read_b128 v[24:27], v159 offset:37760
    ds_read_b128 v[28:31], v159 offset:37824
    ds_read_b128 v[32:35], v159 offset:37888
    ds_read_b128 v[36:39], v159 offset:37952
    s_waitcnt lgkmcnt(3)
    v_mfma_f32_16x16x32_bf16 v[20:23], v[120:123], v[24:27], 0
    s_waitcnt lgkmcnt(2)
    v_mfma_f32_16x16x32_bf16 v[20:23], v[124:127], v[28:31], v[20:23]
    s_waitcnt lgkmcnt(1)
    v_mfma_f32_16x16x32_bf16 v[20:23], v[128:131], v[32:35], v[20:23]
    s_waitcnt lgkmcnt(0)
    v_mfma_f32_16x16x32_bf16 v[20:23], v[132:135], v[36:39], v[20:23]
    s_mov_b32 exec_lo, 0x00030003
    s_mov_b32 exec_hi, 0x00030003
    s_nop 5
    buffer_store_dwordx4 v[20:23], v160, s[28:31], s44 offen sc1
    s_mov_b64 exec, -1
    s_endpgm
L_end:
    s_endpgm
.section .rodata,"a"
.p2align 6
.amdhsa_kernel recurrent_scan__mha_block_cached__glu_gated_bilinear__decode_kernel
  .amdhsa_next_free_vgpr 168
  .amdhsa_next_free_sgpr 96
  .amdhsa_accum_offset 168
  .amdhsa_group_segment_fixed_size 0
  .amdhsa_kernarg_size 96
  .amdhsa_user_sgpr_count 2
  .amdhsa_user_sgpr_kernarg_segment_ptr 1
  .amdhsa_system_sgpr_workgroup_id_x 1
  .amdhsa_float_denorm_mode_32 3
.end_amdhsa_kernel
```
